```python
import torch

def _softmax(x, axis=-1):
    return torch.softmax(x, dim=axis)
def _gelu(x):
    return torch.nn.functional.gelu(x, approximate="tanh")
def _silu(x):
    return torch.nn.functional.silu(x)
def _sigmoid(x):
    return torch.sigmoid(x)
def _layernorm(x, axis=-1, eps=1e-5):
    m = x.mean(dim=axis, keepdim=True)
    v = x.var(dim=axis, keepdim=True, unbiased=False)
    return (x - m) / torch.sqrt(v + eps)
def _scatter_add(tgt, idx, src, axis=0):
    return tgt.clone().index_add_(axis, idx, src)
def _segment_sum(src, seg, n):
    out = torch.zeros((n,) + src.shape[1:], dtype=src.dtype)
    return out.index_add_(0, seg, src)
def _pad(x, pw):
    flat = tuple(v for pair in reversed(pw) for v in pair)
    return torch.nn.functional.pad(x, flat)

kernel_name = 'concat_heads__sliding_block_cached__mha_block_cached__decode'

def setup_inputs():

    _w = (lambda a: (lambda t: t.to(torch.bfloat16) if t.is_floating_point() else t)(torch.as_tensor(a)))
    def _A_setup():
        B, Sq, D = 4, 1, 512
        Hq, Hkv, Sk, Dh = 32, 8, 8192, 128
        assert Hq % Hkv == 0, (Hq, Hkv)
        return {
            "x": _w((lambda *s: torch.randn(*s, dtype=torch.bfloat16) * 0.8)(B, Sq, D)),
            "k_cache": _w((lambda *s: torch.randn(*s, dtype=torch.bfloat16) * 1.6)(B, Hkv, Sk, Dh)),
            "v_cache": _w((lambda *s: torch.randn(*s, dtype=torch.bfloat16) * 0.2)(B, Hkv, Sk, Dh)),
            "wq": _w((lambda *s: torch.randn(*s, dtype=torch.bfloat16) * 1.6)(D, Hq * Dh) * (D ** -0.5)),
            "wo": _w((lambda *s: torch.randn(*s, dtype=torch.bfloat16) * 0.2)(Hq * Dh, D) * ((Hq * Dh) ** -0.5)),
        }
    _A_in = _A_setup()

    def _B_setup():
        B, Sq, D = 4, 1, 512
        H, Sk, Dh = 32, 8192, 128
        return {
            "x": _w((lambda *s: torch.randn(*s, dtype=torch.bfloat16) * 0.8)(B, Sq, D)),
            "k_cache": _w((lambda *s: torch.randn(*s, dtype=torch.bfloat16) * 1.6)(B, H, Sk, Dh)),
            "v_cache": _w((lambda *s: torch.randn(*s, dtype=torch.bfloat16) * 0.2)(B, H, Sk, Dh)),
            "wq": _w((lambda *s: torch.randn(*s, dtype=torch.bfloat16) * 1.6)(D, H * Dh) * (D ** -0.5)),
            "wo": _w((lambda *s: torch.randn(*s, dtype=torch.bfloat16) * 0.2)(H * Dh, D) * ((H * Dh) ** -0.5)),
        }
    _B_in = _B_setup()

    return {
        "A_x": _A_in["x"],
        "A_k_cache": _A_in["k_cache"],
        "A_v_cache": _A_in["v_cache"],
        "A_wq": _A_in["wq"],
        "A_wo": _A_in["wo"],
        "B_x": _B_in["x"],
        "B_k_cache": _B_in["k_cache"],
        "B_v_cache": _B_in["v_cache"],
        "B_wq": _B_in["wq"],
        "B_wo": _B_in["wo"],
    }

def reference(A_x, A_k_cache, A_v_cache, A_wq, A_wo, B_x, B_k_cache, B_v_cache, B_wq, B_wo):
    def _A_ref(x, k_cache, v_cache, wq, wo):
        B, Sq, D = x.shape
        Hq, Dh = 32, 128
        Hkv, Sk = k_cache.shape[1], k_cache.shape[2]
        W = min(4096, max(256, Sk // 4))
        rep = Hq // Hkv
        q = (lambda x, *d: x.permute(*d))((x @ wq).reshape(B, Sq, Hq, Dh), 0, 2, 1, 3)
        k = (lambda x, n, axis: torch.repeat_interleave(x, n, dim=axis))(k_cache[:, :, Sk - W:, :], rep, axis=1)
        v = (lambda x, n, axis: torch.repeat_interleave(x, n, dim=axis))(v_cache[:, :, Sk - W:, :], rep, axis=1)
        scores = torch.einsum("bhqd,bhkd->bhqk", q, k) * (Dh ** -0.5)
        p = _softmax(scores, axis=-1)
        o = torch.einsum("bhqk,bhkd->bhqd", p, v)
        return (lambda x, *d: x.permute(*d))(o, 0, 2, 1, 3).reshape(B, Sq, Hq * Dh) @ wo

    def _B_ref(x, k_cache, v_cache, wq, wo):
        B, Sq, D = x.shape
        H, Dh = 32, 128
        q = (lambda x, *d: x.permute(*d))((x @ wq).reshape(B, Sq, H, Dh), 0, 2, 1, 3)
        scores = torch.einsum("bhqd,bhkd->bhqk", q, k_cache) * (Dh ** -0.5)
        p = _softmax(scores, axis=-1)
        o = torch.einsum("bhqk,bhkd->bhqd", p, v_cache)
        return (lambda x, *d: x.permute(*d))(o, 0, 2, 1, 3).reshape(B, Sq, H * Dh) @ wo

    a = _A_ref(A_x, A_k_cache, A_v_cache, A_wq, A_wo)
    b = _B_ref(B_x, B_k_cache, B_v_cache, B_wq, B_wo)
    return torch.concatenate([a, b], axis=-1)
```

```asm
; @launch grid=(256,1,1) block=(384,1,1) lds=120832
.amdgcn_target "amdgcn-amd-amdhsa--gfx950"
.text
.globl concat_heads__sliding_block_cached__mha_block_cached__decode_kernel
.p2align 8
.type concat_heads__sliding_block_cached__mha_block_cached__decode_kernel,@function
concat_heads__sliding_block_cached__mha_block_cached__decode_kernel:
    s_cmp_ge_u32 s2, 256
    s_cbranch_scc1 L_exit
    s_load_dwordx16 s[16:31], s[0:1], 0
    s_load_dwordx8 s[32:39], s[0:1], 64
    s_load_dwordx2 s[40:41], s[0:1], 96
    v_lshrrev_b32 v1, 6, v0
    v_and_b32 v0, 63, v0
    s_lshr_b32 s4, s2, 3
    v_readfirstlane_b32 s3, v1
    s_and_b32 s5, s2, 7
    s_cmp_eq_u32 s3, 0
    s_cbranch_scc1 L_helperB
    s_cmp_eq_u32 s3, 1
    s_cbranch_scc1 L_helperA
L_stream:
    v_lshlrev_b32 v2, 4, v0
    v_bfe_u32 v12, v0, 2, 2
    v_lshlrev_b32 v1, 8, v12
    v_lshrrev_b32 v13, 4, v0
    v_lshl_add_u32 v1, v13, 6, v1
    v_and_b32 v14, 3, v0
    v_lshl_add_u32 v1, v14, 4, v1
    s_lshl_b32 s63, s4, 21
    s_lshl_b32 s6, s5, 2
    s_add_u32 s6, s6, s3
    s_sub_u32 s6, s6, 2
    s_lshr_b32 s72, s4, 0
    s_mul_i32 s72, s72, 40
    s_add_u32 s62, s72, s6
    s_mul_i32 s7, s4, 4
    s_add_u32 s7, s7, s3
    s_sub_u32 s73, s7, 2
    s_waitcnt lgkmcnt(0)
    s_mov_b32 s44, s28
    s_mov_b32 s45, s29
    s_mov_b32 s46, 0x10000000
    s_mov_b32 s47, 0x20000
    s_mov_b32 s48, s30
    s_mov_b32 s49, s31
    s_mov_b32 s50, 0x10000000
    s_mov_b32 s51, 0x20000
    s_mov_b32 s76, s62
    s_and_b32 s6, s62, 2047
    s_lshr_b32 s7, s6, 9
    s_lshl_b32 s7, s7, 26
    s_and_b32 s6, s6, 511
    s_lshl_b32 s6, s6, 12
    s_or_b32 s6, s6, s7
    s_or_b32 s10, s6, s63
    s_add_u32 s62, s62, 32
    s_and_b32 s6, s62, 2047
    s_lshr_b32 s7, s6, 9
    s_lshl_b32 s7, s7, 26
    s_and_b32 s6, s6, 511
    s_lshl_b32 s6, s6, 12
    s_or_b32 s6, s6, s7
    s_or_b32 s11, s6, s63
    s_add_u32 s62, s62, 32
    buffer_load_dwordx4 v[56:59], v1, s[44:47], s10 offen offset:0 nt
    buffer_load_dwordx4 v[60:63], v1, s[44:47], s10 offen offset:1024 nt
    buffer_load_dwordx4 v[64:67], v1, s[44:47], s10 offen offset:2048 nt
    buffer_load_dwordx4 v[68:71], v1, s[44:47], s10 offen offset:3072 nt
    buffer_load_dwordx4 v[72:75], v1, s[44:47], s11 offen offset:0 nt
    buffer_load_dwordx4 v[76:79], v1, s[44:47], s11 offen offset:1024 nt
    buffer_load_dwordx4 v[80:83], v1, s[44:47], s11 offen offset:2048 nt
    buffer_load_dwordx4 v[84:87], v1, s[44:47], s11 offen offset:3072 nt
    s_barrier
    s_mov_b32 s52, s18
    s_mov_b32 s53, s19
    s_mov_b32 s54, 0x4000000
    s_mov_b32 s55, 0x20000
    s_mov_b32 s56, s20
    s_mov_b32 s57, s21
    s_mov_b32 s58, 0x4000000
    s_mov_b32 s59, 0x20000
    s_and_b32 s6, s4, 3
    s_lshl_b32 s6, s6, 3
    s_lshr_b32 s7, s4, 2
    s_add_u32 s6, s6, s7
    s_lshl_b32 s6, s6, 21
    s_add_u32 s64, s6, 0x180000
    s_mul_i32 s6, s4, 14336
    s_add_u32 s6, s6, 0x180400
    s_add_u32 s60, s40, s6
    s_addc_u32 s61, s41, 0
    s_mov_b32 s65, 0x3e0293ee
    s_mov_b32 s68, 0x000f000f
    s_mov_b32 s69, 0x000f000f
    v_mov_b32 v10, 0xff800000
    v_mov_b32 v5, 0x7149f2ca
    v_mov_b32 v7, 0x7149f2ca
    v_mov_b32 v6, 0
    v_mov_b32 v8, 0xff800000
    s_mov_b32 s78, 0x22222222
    s_mov_b32 s79, 0x22222222
    s_mov_b32 s80, 0x44444444
    s_mov_b32 s81, 0x44444444
    s_mov_b32 s82, 0x88888888
    s_mov_b32 s83, 0x88888888
    s_lshl_b32 s6, s3, 14
    s_add_u32 s74, s6, 22528
    v_lshl_add_u32 v15, v0, 2, s74
    v_mov_b32 v24, 0
    v_mov_b32 v25, 0
    v_mov_b32 v26, 0
    v_mov_b32 v27, 0
    v_mov_b32 v28, 0
    v_mov_b32 v29, 0
    v_mov_b32 v30, 0
    v_mov_b32 v31, 0
    v_mov_b32 v32, 0
    v_mov_b32 v33, 0
    v_mov_b32 v34, 0
    v_mov_b32 v35, 0
    v_mov_b32 v36, 0
    v_mov_b32 v37, 0
    v_mov_b32 v38, 0
    v_mov_b32 v39, 0
    v_lshlrev_b32 v11, 4, v13
    v_and_b32 v3, 1, v0
    v_lshlrev_b32 v3, 4, v3
    v_mov_b32 v40, 0xffff
    v_lshlrev_b32 v40, v3, v40
    v_cmp_gt_u32 vcc, 2, v14
    s_nop 1
    v_cndmask_b32 v3, 0, v40, vcc
    v_cndmask_b32 v4, v40, 0, vcc
    s_waitcnt vmcnt(0)
    s_and_b32 s6, s62, 2047
    s_lshr_b32 s7, s6, 9
    s_lshl_b32 s7, s7, 26
    s_and_b32 s6, s6, 511
    s_lshl_b32 s6, s6, 12
    s_or_b32 s6, s6, s7
    s_or_b32 s10, s6, s63
    s_add_u32 s62, s62, 32
    s_and_b32 s6, s62, 2047
    s_lshr_b32 s7, s6, 9
    s_lshl_b32 s7, s7, 26
    s_and_b32 s6, s6, 511
    s_lshl_b32 s6, s6, 12
    s_or_b32 s6, s6, s7
    s_or_b32 s11, s6, s63
    s_add_u32 s62, s62, 32
    buffer_load_dwordx4 v[88:91], v1, s[44:47], s10 offen offset:0 nt
    buffer_load_dwordx4 v[92:95], v1, s[44:47], s10 offen offset:1024 nt
    buffer_load_dwordx4 v[96:99], v1, s[44:47], s10 offen offset:2048 nt
    buffer_load_dwordx4 v[100:103], v1, s[44:47], s10 offen offset:3072 nt
    buffer_load_dwordx4 v[104:107], v1, s[44:47], s11 offen offset:0 nt
    buffer_load_dwordx4 v[108:111], v1, s[44:47], s11 offen offset:1024 nt
    buffer_load_dwordx4 v[112:115], v1, s[44:47], s11 offen offset:2048 nt
    buffer_load_dwordx4 v[116:119], v1, s[44:47], s11 offen offset:3072 nt
    s_waitcnt vmcnt(0)
    s_and_b32 s6, s62, 2047
    s_lshr_b32 s7, s6, 9
    s_lshl_b32 s7, s7, 26
    s_and_b32 s6, s6, 511
    s_lshl_b32 s6, s6, 12
    s_or_b32 s6, s6, s7
    s_or_b32 s10, s6, s63
    s_add_u32 s62, s62, 32
    s_and_b32 s6, s62, 2047
    s_lshr_b32 s7, s6, 9
    s_lshl_b32 s7, s7, 26
    s_and_b32 s6, s6, 511
    s_lshl_b32 s6, s6, 12
    s_or_b32 s6, s6, s7
    s_or_b32 s11, s6, s63
    s_add_u32 s62, s62, 32
    buffer_load_dwordx4 v[120:123], v1, s[44:47], s10 offen offset:0 nt
    buffer_load_dwordx4 v[124:127], v1, s[44:47], s10 offen offset:1024 nt
    buffer_load_dwordx4 v[128:131], v1, s[44:47], s10 offen offset:2048 nt
    buffer_load_dwordx4 v[132:135], v1, s[44:47], s10 offen offset:3072 nt
    buffer_load_dwordx4 v[136:139], v1, s[44:47], s11 offen offset:0 nt
    buffer_load_dwordx4 v[140:143], v1, s[44:47], s11 offen offset:1024 nt
    buffer_load_dwordx4 v[144:147], v1, s[44:47], s11 offen offset:2048 nt
    buffer_load_dwordx4 v[148:151], v1, s[44:47], s11 offen offset:3072 nt
    s_waitcnt vmcnt(0)
    s_and_b32 s6, s62, 2047
    s_lshr_b32 s7, s6, 9
    s_lshl_b32 s7, s7, 26
    s_and_b32 s6, s6, 511
    s_lshl_b32 s6, s6, 12
    s_or_b32 s6, s6, s7
    s_or_b32 s10, s6, s63
    s_add_u32 s62, s62, 32
    s_and_b32 s6, s62, 2047
    s_lshr_b32 s7, s6, 9
    s_lshl_b32 s7, s7, 26
    s_and_b32 s6, s6, 511
    s_lshl_b32 s6, s6, 12
    s_or_b32 s6, s6, s7
    s_or_b32 s11, s6, s63
    s_add_u32 s62, s62, 32
    buffer_load_dwordx4 v[152:155], v1, s[44:47], s10 offen offset:0 nt
    buffer_load_dwordx4 v[156:159], v1, s[44:47], s10 offen offset:1024 nt
    buffer_load_dwordx4 v[160:163], v1, s[44:47], s10 offen offset:2048 nt
    buffer_load_dwordx4 v[164:167], v1, s[44:47], s10 offen offset:3072 nt
    buffer_load_dwordx4 v[168:171], v1, s[44:47], s11 offen offset:0 nt
    buffer_load_dwordx4 v[172:175], v1, s[44:47], s11 offen offset:1024 nt
    buffer_load_dwordx4 v[176:179], v1, s[44:47], s11 offen offset:2048 nt
    buffer_load_dwordx4 v[180:183], v1, s[44:47], s11 offen offset:3072 nt
    s_waitcnt vmcnt(0)
    s_and_b32 s6, s62, 2047
    s_lshr_b32 s7, s6, 9
    s_lshl_b32 s7, s7, 26
    s_and_b32 s6, s6, 511
    s_lshl_b32 s6, s6, 12
    s_or_b32 s6, s6, s7
    s_or_b32 s10, s6, s63
    s_add_u32 s62, s62, 32
    s_and_b32 s6, s62, 2047
    s_lshr_b32 s7, s6, 9
    s_lshl_b32 s7, s7, 26
    s_and_b32 s6, s6, 511
    s_lshl_b32 s6, s6, 12
    s_or_b32 s6, s6, s7
    s_or_b32 s11, s6, s63
    s_add_u32 s62, s62, 32
    buffer_load_dwordx4 v[184:187], v1, s[44:47], s10 offen offset:0 nt
    buffer_load_dwordx4 v[188:191], v1, s[44:47], s10 offen offset:1024 nt
    buffer_load_dwordx4 v[192:195], v1, s[44:47], s10 offen offset:2048 nt
    buffer_load_dwordx4 v[196:199], v1, s[44:47], s10 offen offset:3072 nt
    buffer_load_dwordx4 v[200:203], v1, s[44:47], s11 offen offset:0 nt
    buffer_load_dwordx4 v[204:207], v1, s[44:47], s11 offen offset:1024 nt
    buffer_load_dwordx4 v[208:211], v1, s[44:47], s11 offen offset:2048 nt
    buffer_load_dwordx4 v[212:215], v1, s[44:47], s11 offen offset:3072 nt
    s_waitcnt vmcnt(0)
    s_and_b32 s6, s62, 2047
    s_lshr_b32 s7, s6, 9
    s_lshl_b32 s7, s7, 26
    s_and_b32 s6, s6, 511
    s_lshl_b32 s6, s6, 12
    s_or_b32 s6, s6, s7
    s_or_b32 s10, s6, s63
    s_add_u32 s62, s62, 32
    s_and_b32 s6, s62, 2047
    s_lshr_b32 s7, s6, 9
    s_lshl_b32 s7, s7, 26
    s_and_b32 s6, s6, 511
    s_lshl_b32 s6, s6, 12
    s_or_b32 s6, s6, s7
    s_or_b32 s11, s6, s63
    s_add_u32 s62, s62, 32
    buffer_load_dwordx4 v[216:219], v1, s[44:47], s10 offen offset:0 nt
    buffer_load_dwordx4 v[220:223], v1, s[44:47], s10 offen offset:1024 nt
    buffer_load_dwordx4 v[224:227], v1, s[44:47], s10 offen offset:2048 nt
    buffer_load_dwordx4 v[228:231], v1, s[44:47], s10 offen offset:3072 nt
    buffer_load_dwordx4 v[232:235], v1, s[44:47], s11 offen offset:0 nt
    buffer_load_dwordx4 v[236:239], v1, s[44:47], s11 offen offset:1024 nt
    buffer_load_dwordx4 v[240:243], v1, s[44:47], s11 offen offset:2048 nt
    buffer_load_dwordx4 v[244:247], v1, s[44:47], s11 offen offset:3072 nt
    s_mov_b32 s7, 524288
    v_mov_b32 v12, 2048
L_wait_1:
    ds_read_b32 v13, v12 offset:12
    s_waitcnt lgkmcnt(0)
    v_readfirstlane_b32 s6, v13
    s_cmp_lg_u32 s6, 0
    s_cbranch_scc1 L_set_2
    s_sleep 1
    s_sub_u32 s7, s7, 1
    s_cmp_lg_u32 s7, 0
    s_cbranch_scc1 L_wait_1
L_set_2:
    v_mov_b32 v12, 2048
    ds_read_b128 v[16:19], v1 offset:0
    ds_read_b32 v13, v12 offset:8
    s_waitcnt lgkmcnt(0)
    v_readfirstlane_b32 s75, v13
    s_mov_b32 s70, 1
    s_atomic_add s70, s[60:61], 0 glc
    s_mov_b32 s8, s76
    v_mfma_f32_16x16x32_bf16 v[40:43], v[56:59], v[16:19], 0
    v_mfma_f32_16x16x32_bf16 v[44:47], v[60:63], v[16:19], 0
    v_mfma_f32_16x16x32_bf16 v[48:51], v[64:67], v[16:19], 0
    v_mfma_f32_16x16x32_bf16 v[52:55], v[68:71], v[16:19], 0
    s_bfe_u32 s6, s76, 0x20009
    s_lshl_b32 s6, s6, 2
    s_lshl_b64 s[66:67], s[68:69], s6
    s_add_u32 s76, s76, 32
    s_nop 0
    v_mov_b32_dpp v40, v40 quad_perm:[0,0,0,0] row_mask:0xf bank_mask:0xf
    v_mov_b32_dpp v44, v44 quad_perm:[0,0,0,0] row_mask:0xf bank_mask:0xf
    v_mov_b32_dpp v48, v48 quad_perm:[0,0,0,0] row_mask:0xf bank_mask:0xf
    v_mov_b32_dpp v52, v52 quad_perm:[0,0,0,0] row_mask:0xf bank_mask:0xf
    v_add_f32_dpp v40, v41, v40 quad_perm:[1,1,1,1] row_mask:0xf bank_mask:0xf
    v_add_f32_dpp v44, v45, v44 quad_perm:[1,1,1,1] row_mask:0xf bank_mask:0xf
    v_add_f32_dpp v48, v49, v48 quad_perm:[1,1,1,1] row_mask:0xf bank_mask:0xf
    v_add_f32_dpp v52, v53, v52 quad_perm:[1,1,1,1] row_mask:0xf bank_mask:0xf
    v_add_f32_dpp v40, v42, v40 quad_perm:[2,2,2,2] row_mask:0xf bank_mask:0xf
    v_add_f32_dpp v44, v46, v44 quad_perm:[2,2,2,2] row_mask:0xf bank_mask:0xf
    v_add_f32_dpp v48, v50, v48 quad_perm:[2,2,2,2] row_mask:0xf bank_mask:0xf
    v_add_f32_dpp v52, v54, v52 quad_perm:[2,2,2,2] row_mask:0xf bank_mask:0xf
    v_add_f32_dpp v40, v43, v40 quad_perm:[3,3,3,3] row_mask:0xf bank_mask:0xf
    v_add_f32_dpp v44, v47, v44 quad_perm:[3,3,3,3] row_mask:0xf bank_mask:0xf
    v_add_f32_dpp v48, v51, v48 quad_perm:[3,3,3,3] row_mask:0xf bank_mask:0xf
    v_add_f32_dpp v52, v55, v52 quad_perm:[3,3,3,3] row_mask:0xf bank_mask:0xf
    v_max3_f32 v12, v40, v44, v48
    v_cndmask_b32 v13, v40, v44, s[78:79]
    v_max_f32 v12, v12, v52
    v_cndmask_b32 v13, v13, v48, s[80:81]
    v_cndmask_b32 v12, v10, v12, s[66:67]
    v_cndmask_b32 v13, v13, v52, s[82:83]
    v_max_f32 v8, v8, v12
    ds_write_b32 v15, v13 offset:0
    v_mfma_f32_16x16x32_bf16 v[40:43], v[72:75], v[16:19], 0
    v_mfma_f32_16x16x32_bf16 v[44:47], v[76:79], v[16:19], 0
    v_mfma_f32_16x16x32_bf16 v[48:51], v[80:83], v[16:19], 0
    v_mfma_f32_16x16x32_bf16 v[52:55], v[84:87], v[16:19], 0
    s_and_b32 s6, s62, 2047
    s_lshr_b32 s7, s6, 9
    s_lshl_b32 s7, s7, 26
    s_and_b32 s6, s6, 511
    s_lshl_b32 s6, s6, 12
    s_or_b32 s6, s6, s7
    s_or_b32 s10, s6, s63
    s_add_u32 s62, s62, 32
    s_and_b32 s6, s62, 2047
    s_lshr_b32 s7, s6, 9
    s_lshl_b32 s7, s7, 26
    s_and_b32 s6, s6, 511
    s_lshl_b32 s6, s6, 12
    s_or_b32 s6, s6, s7
    s_or_b32 s11, s6, s63
    s_add_u32 s62, s62, 32
    buffer_load_dwordx4 v[56:59], v1, s[44:47], s10 offen offset:0 nt
    buffer_load_dwordx4 v[60:63], v1, s[44:47], s10 offen offset:1024 nt
    buffer_load_dwordx4 v[64:67], v1, s[44:47], s10 offen offset:2048 nt
    buffer_load_dwordx4 v[68:71], v1, s[44:47], s10 offen offset:3072 nt
    buffer_load_dwordx4 v[72:75], v1, s[44:47], s11 offen offset:0 nt
    buffer_load_dwordx4 v[76:79], v1, s[44:47], s11 offen offset:1024 nt
    buffer_load_dwordx4 v[80:83], v1, s[44:47], s11 offen offset:2048 nt
    buffer_load_dwordx4 v[84:87], v1, s[44:47], s11 offen offset:3072 nt
    s_bfe_u32 s6, s76, 0x20009
    s_lshl_b32 s6, s6, 2
    s_lshl_b64 s[66:67], s[68:69], s6
    s_add_u32 s76, s76, 32
    s_nop 0
    v_mov_b32_dpp v40, v40 quad_perm:[0,0,0,0] row_mask:0xf bank_mask:0xf
    v_mov_b32_dpp v44, v44 quad_perm:[0,0,0,0] row_mask:0xf bank_mask:0xf
    v_mov_b32_dpp v48, v48 quad_perm:[0,0,0,0] row_mask:0xf bank_mask:0xf
    v_mov_b32_dpp v52, v52 quad_perm:[0,0,0,0] row_mask:0xf bank_mask:0xf
    v_add_f32_dpp v40, v41, v40 quad_perm:[1,1,1,1] row_mask:0xf bank_mask:0xf
    v_add_f32_dpp v44, v45, v44 quad_perm:[1,1,1,1] row_mask:0xf bank_mask:0xf
    v_add_f32_dpp v48, v49, v48 quad_perm:[1,1,1,1] row_mask:0xf bank_mask:0xf
    v_add_f32_dpp v52, v53, v52 quad_perm:[1,1,1,1] row_mask:0xf bank_mask:0xf
    v_add_f32_dpp v40, v42, v40 quad_perm:[2,2,2,2] row_mask:0xf bank_mask:0xf
    v_add_f32_dpp v44, v46, v44 quad_perm:[2,2,2,2] row_mask:0xf bank_mask:0xf
    v_add_f32_dpp v48, v50, v48 quad_perm:[2,2,2,2] row_mask:0xf bank_mask:0xf
    v_add_f32_dpp v52, v54, v52 quad_perm:[2,2,2,2] row_mask:0xf bank_mask:0xf
    v_add_f32_dpp v40, v43, v40 quad_perm:[3,3,3,3] row_mask:0xf bank_mask:0xf
    v_add_f32_dpp v44, v47, v44 quad_perm:[3,3,3,3] row_mask:0xf bank_mask:0xf
    v_add_f32_dpp v48, v51, v48 quad_perm:[3,3,3,3] row_mask:0xf bank_mask:0xf
    v_add_f32_dpp v52, v55, v52 quad_perm:[3,3,3,3] row_mask:0xf bank_mask:0xf
    v_max3_f32 v12, v40, v44, v48
    v_cndmask_b32 v14, v40, v44, s[78:79]
    v_max_f32 v12, v12, v52
    v_cndmask_b32 v14, v14, v48, s[80:81]
    v_cndmask_b32 v12, v10, v12, s[66:67]
    v_cndmask_b32 v14, v14, v52, s[82:83]
    v_max_f32 v8, v8, v12
    ds_write_b32 v15, v14 offset:256
    v_add_u32 v15, 512, v15
    v_mfma_f32_16x16x32_bf16 v[40:43], v[88:91], v[16:19], 0
    v_mfma_f32_16x16x32_bf16 v[44:47], v[92:95], v[16:19], 0
    v_mfma_f32_16x16x32_bf16 v[48:51], v[96:99], v[16:19], 0
    v_mfma_f32_16x16x32_bf16 v[52:55], v[100:103], v[16:19], 0
    s_bfe_u32 s6, s76, 0x20009
    s_lshl_b32 s6, s6, 2
    s_lshl_b64 s[66:67], s[68:69], s6
    s_add_u32 s76, s76, 32
    s_nop 0
    v_mov_b32_dpp v40, v40 quad_perm:[0,0,0,0] row_mask:0xf bank_mask:0xf
    v_mov_b32_dpp v44, v44 quad_perm:[0,0,0,0] row_mask:0xf bank_mask:0xf
    v_mov_b32_dpp v48, v48 quad_perm:[0,0,0,0] row_mask:0xf bank_mask:0xf
    v_mov_b32_dpp v52, v52 quad_perm:[0,0,0,0] row_mask:0xf bank_mask:0xf
    v_add_f32_dpp v40, v41, v40 quad_perm:[1,1,1,1] row_mask:0xf bank_mask:0xf
    v_add_f32_dpp v44, v45, v44 quad_perm:[1,1,1,1] row_mask:0xf bank_mask:0xf
    v_add_f32_dpp v48, v49, v48 quad_perm:[1,1,1,1] row_mask:0xf bank_mask:0xf
    v_add_f32_dpp v52, v53, v52 quad_perm:[1,1,1,1] row_mask:0xf bank_mask:0xf
    v_add_f32_dpp v40, v42, v40 quad_perm:[2,2,2,2] row_mask:0xf bank_mask:0xf
    v_add_f32_dpp v44, v46, v44 quad_perm:[2,2,2,2] row_mask:0xf bank_mask:0xf
    v_add_f32_dpp v48, v50, v48 quad_perm:[2,2,2,2] row_mask:0xf bank_mask:0xf
    v_add_f32_dpp v52, v54, v52 quad_perm:[2,2,2,2] row_mask:0xf bank_mask:0xf
    v_add_f32_dpp v40, v43, v40 quad_perm:[3,3,3,3] row_mask:0xf bank_mask:0xf
    v_add_f32_dpp v44, v47, v44 quad_perm:[3,3,3,3] row_mask:0xf bank_mask:0xf
    v_add_f32_dpp v48, v51, v48 quad_perm:[3,3,3,3] row_mask:0xf bank_mask:0xf
    v_add_f32_dpp v52, v55, v52 quad_perm:[3,3,3,3] row_mask:0xf bank_mask:0xf
    v_max3_f32 v12, v40, v44, v48
    v_cndmask_b32 v13, v40, v44, s[78:79]
    v_max_f32 v12, v12, v52
    v_cndmask_b32 v13, v13, v48, s[80:81]
    v_cndmask_b32 v12, v10, v12, s[66:67]
    v_cndmask_b32 v13, v13, v52, s[82:83]
    v_max_f32 v8, v8, v12
    ds_write_b32 v15, v13 offset:0
    v_mfma_f32_16x16x32_bf16 v[40:43], v[104:107], v[16:19], 0
    v_mfma_f32_16x16x32_bf16 v[44:47], v[108:111], v[16:19], 0
    v_mfma_f32_16x16x32_bf16 v[48:51], v[112:115], v[16:19], 0
    v_mfma_f32_16x16x32_bf16 v[52:55], v[116:119], v[16:19], 0
    s_bfe_u32 s6, s76, 0x20009
    s_lshl_b32 s6, s6, 2
    s_lshl_b64 s[66:67], s[68:69], s6
    s_add_u32 s76, s76, 32
    s_nop 0
    v_mov_b32_dpp v40, v40 quad_perm:[0,0,0,0] row_mask:0xf bank_mask:0xf
    v_mov_b32_dpp v44, v44 quad_perm:[0,0,0,0] row_mask:0xf bank_mask:0xf
    v_mov_b32_dpp v48, v48 quad_perm:[0,0,0,0] row_mask:0xf bank_mask:0xf
    v_mov_b32_dpp v52, v52 quad_perm:[0,0,0,0] row_mask:0xf bank_mask:0xf
    v_add_f32_dpp v40, v41, v40 quad_perm:[1,1,1,1] row_mask:0xf bank_mask:0xf
    v_add_f32_dpp v44, v45, v44 quad_perm:[1,1,1,1] row_mask:0xf bank_mask:0xf
    v_add_f32_dpp v48, v49, v48 quad_perm:[1,1,1,1] row_mask:0xf bank_mask:0xf
    v_add_f32_dpp v52, v53, v52 quad_perm:[1,1,1,1] row_mask:0xf bank_mask:0xf
    v_add_f32_dpp v40, v42, v40 quad_perm:[2,2,2,2] row_mask:0xf bank_mask:0xf
    v_add_f32_dpp v44, v46, v44 quad_perm:[2,2,2,2] row_mask:0xf bank_mask:0xf
    v_add_f32_dpp v48, v50, v48 quad_perm:[2,2,2,2] row_mask:0xf bank_mask:0xf
    v_add_f32_dpp v52, v54, v52 quad_perm:[2,2,2,2] row_mask:0xf bank_mask:0xf
    v_add_f32_dpp v40, v43, v40 quad_perm:[3,3,3,3] row_mask:0xf bank_mask:0xf
    v_add_f32_dpp v44, v47, v44 quad_perm:[3,3,3,3] row_mask:0xf bank_mask:0xf
    v_add_f32_dpp v48, v51, v48 quad_perm:[3,3,3,3] row_mask:0xf bank_mask:0xf
    v_add_f32_dpp v52, v55, v52 quad_perm:[3,3,3,3] row_mask:0xf bank_mask:0xf
    v_max3_f32 v12, v40, v44, v48
    v_cndmask_b32 v14, v40, v44, s[78:79]
    v_max_f32 v12, v12, v52
    v_cndmask_b32 v14, v14, v48, s[80:81]
    v_cndmask_b32 v12, v10, v12, s[66:67]
    v_cndmask_b32 v14, v14, v52, s[82:83]
    v_max_f32 v8, v8, v12
    ds_write_b32 v15, v14 offset:256
    v_add_u32 v15, 512, v15
    v_mfma_f32_16x16x32_bf16 v[40:43], v[120:123], v[16:19], 0
    v_mfma_f32_16x16x32_bf16 v[44:47], v[124:127], v[16:19], 0
    v_mfma_f32_16x16x32_bf16 v[48:51], v[128:131], v[16:19], 0
    v_mfma_f32_16x16x32_bf16 v[52:55], v[132:135], v[16:19], 0
    s_bfe_u32 s6, s76, 0x20009
    s_lshl_b32 s6, s6, 2
    s_lshl_b64 s[66:67], s[68:69], s6
    s_add_u32 s76, s76, 32
    s_nop 0
    v_mov_b32_dpp v40, v40 quad_perm:[0,0,0,0] row_mask:0xf bank_mask:0xf
    v_mov_b32_dpp v44, v44 quad_perm:[0,0,0,0] row_mask:0xf bank_mask:0xf
    v_mov_b32_dpp v48, v48 quad_perm:[0,0,0,0] row_mask:0xf bank_mask:0xf
    v_mov_b32_dpp v52, v52 quad_perm:[0,0,0,0] row_mask:0xf bank_mask:0xf
    v_add_f32_dpp v40, v41, v40 quad_perm:[1,1,1,1] row_mask:0xf bank_mask:0xf
    v_add_f32_dpp v44, v45, v44 quad_perm:[1,1,1,1] row_mask:0xf bank_mask:0xf
    v_add_f32_dpp v48, v49, v48 quad_perm:[1,1,1,1] row_mask:0xf bank_mask:0xf
    v_add_f32_dpp v52, v53, v52 quad_perm:[1,1,1,1] row_mask:0xf bank_mask:0xf
    v_add_f32_dpp v40, v42, v40 quad_perm:[2,2,2,2] row_mask:0xf bank_mask:0xf
    v_add_f32_dpp v44, v46, v44 quad_perm:[2,2,2,2] row_mask:0xf bank_mask:0xf
    v_add_f32_dpp v48, v50, v48 quad_perm:[2,2,2,2] row_mask:0xf bank_mask:0xf
    v_add_f32_dpp v52, v54, v52 quad_perm:[2,2,2,2] row_mask:0xf bank_mask:0xf
    v_add_f32_dpp v40, v43, v40 quad_perm:[3,3,3,3] row_mask:0xf bank_mask:0xf
    v_add_f32_dpp v44, v47, v44 quad_perm:[3,3,3,3] row_mask:0xf bank_mask:0xf
    v_add_f32_dpp v48, v51, v48 quad_perm:[3,3,3,3] row_mask:0xf bank_mask:0xf
    v_add_f32_dpp v52, v55, v52 quad_perm:[3,3,3,3] row_mask:0xf bank_mask:0xf
    v_max3_f32 v12, v40, v44, v48
    v_cndmask_b32 v13, v40, v44, s[78:79]
    v_max_f32 v12, v12, v52
    v_cndmask_b32 v13, v13, v48, s[80:81]
    v_cndmask_b32 v12, v10, v12, s[66:67]
    v_cndmask_b32 v13, v13, v52, s[82:83]
    v_max_f32 v8, v8, v12
    ds_write_b32 v15, v13 offset:0
    v_mfma_f32_16x16x32_bf16 v[40:43], v[136:139], v[16:19], 0
    v_mfma_f32_16x16x32_bf16 v[44:47], v[140:143], v[16:19], 0
    v_mfma_f32_16x16x32_bf16 v[48:51], v[144:147], v[16:19], 0
    v_mfma_f32_16x16x32_bf16 v[52:55], v[148:151], v[16:19], 0
    s_bfe_u32 s6, s76, 0x20009
    s_lshl_b32 s6, s6, 2
    s_lshl_b64 s[66:67], s[68:69], s6
    s_add_u32 s76, s76, 32
    s_nop 0
    v_mov_b32_dpp v40, v40 quad_perm:[0,0,0,0] row_mask:0xf bank_mask:0xf
    v_mov_b32_dpp v44, v44 quad_perm:[0,0,0,0] row_mask:0xf bank_mask:0xf
    v_mov_b32_dpp v48, v48 quad_perm:[0,0,0,0] row_mask:0xf bank_mask:0xf
    v_mov_b32_dpp v52, v52 quad_perm:[0,0,0,0] row_mask:0xf bank_mask:0xf
    v_add_f32_dpp v40, v41, v40 quad_perm:[1,1,1,1] row_mask:0xf bank_mask:0xf
    v_add_f32_dpp v44, v45, v44 quad_perm:[1,1,1,1] row_mask:0xf bank_mask:0xf
    v_add_f32_dpp v48, v49, v48 quad_perm:[1,1,1,1] row_mask:0xf bank_mask:0xf
    v_add_f32_dpp v52, v53, v52 quad_perm:[1,1,1,1] row_mask:0xf bank_mask:0xf
    v_add_f32_dpp v40, v42, v40 quad_perm:[2,2,2,2] row_mask:0xf bank_mask:0xf
    v_add_f32_dpp v44, v46, v44 quad_perm:[2,2,2,2] row_mask:0xf bank_mask:0xf
    v_add_f32_dpp v48, v50, v48 quad_perm:[2,2,2,2] row_mask:0xf bank_mask:0xf
    v_add_f32_dpp v52, v54, v52 quad_perm:[2,2,2,2] row_mask:0xf bank_mask:0xf
    v_add_f32_dpp v40, v43, v40 quad_perm:[3,3,3,3] row_mask:0xf bank_mask:0xf
    v_add_f32_dpp v44, v47, v44 quad_perm:[3,3,3,3] row_mask:0xf bank_mask:0xf
    v_add_f32_dpp v48, v51, v48 quad_perm:[3,3,3,3] row_mask:0xf bank_mask:0xf
    v_add_f32_dpp v52, v55, v52 quad_perm:[3,3,3,3] row_mask:0xf bank_mask:0xf
    v_max3_f32 v12, v40, v44, v48
    v_cndmask_b32 v14, v40, v44, s[78:79]
    v_max_f32 v12, v12, v52
    v_cndmask_b32 v14, v14, v48, s[80:81]
    v_cndmask_b32 v12, v10, v12, s[66:67]
    v_cndmask_b32 v14, v14, v52, s[82:83]
    v_max_f32 v8, v8, v12
    ds_write_b32 v15, v14 offset:256
    v_add_u32 v15, 512, v15
    v_mfma_f32_16x16x32_bf16 v[40:43], v[152:155], v[16:19], 0
    v_mfma_f32_16x16x32_bf16 v[44:47], v[156:159], v[16:19], 0
    v_mfma_f32_16x16x32_bf16 v[48:51], v[160:163], v[16:19], 0
    v_mfma_f32_16x16x32_bf16 v[52:55], v[164:167], v[16:19], 0
    s_bfe_u32 s6, s76, 0x20009
    s_lshl_b32 s6, s6, 2
    s_lshl_b64 s[66:67], s[68:69], s6
    s_add_u32 s76, s76, 32
    s_nop 0
    v_mov_b32_dpp v40, v40 quad_perm:[0,0,0,0] row_mask:0xf bank_mask:0xf
    v_mov_b32_dpp v44, v44 quad_perm:[0,0,0,0] row_mask:0xf bank_mask:0xf
    v_mov_b32_dpp v48, v48 quad_perm:[0,0,0,0] row_mask:0xf bank_mask:0xf
    v_mov_b32_dpp v52, v52 quad_perm:[0,0,0,0] row_mask:0xf bank_mask:0xf
    v_add_f32_dpp v40, v41, v40 quad_perm:[1,1,1,1] row_mask:0xf bank_mask:0xf
    v_add_f32_dpp v44, v45, v44 quad_perm:[1,1,1,1] row_mask:0xf bank_mask:0xf
    v_add_f32_dpp v48, v49, v48 quad_perm:[1,1,1,1] row_mask:0xf bank_mask:0xf
    v_add_f32_dpp v52, v53, v52 quad_perm:[1,1,1,1] row_mask:0xf bank_mask:0xf
    v_add_f32_dpp v40, v42, v40 quad_perm:[2,2,2,2] row_mask:0xf bank_mask:0xf
    v_add_f32_dpp v44, v46, v44 quad_perm:[2,2,2,2] row_mask:0xf bank_mask:0xf
    v_add_f32_dpp v48, v50, v48 quad_perm:[2,2,2,2] row_mask:0xf bank_mask:0xf
    v_add_f32_dpp v52, v54, v52 quad_perm:[2,2,2,2] row_mask:0xf bank_mask:0xf
    v_add_f32_dpp v40, v43, v40 quad_perm:[3,3,3,3] row_mask:0xf bank_mask:0xf
    v_add_f32_dpp v44, v47, v44 quad_perm:[3,3,3,3] row_mask:0xf bank_mask:0xf
    v_add_f32_dpp v48, v51, v48 quad_perm:[3,3,3,3] row_mask:0xf bank_mask:0xf
    v_add_f32_dpp v52, v55, v52 quad_perm:[3,3,3,3] row_mask:0xf bank_mask:0xf
    v_max3_f32 v12, v40, v44, v48
    v_cndmask_b32 v13, v40, v44, s[78:79]
    v_max_f32 v12, v12, v52
    v_cndmask_b32 v13, v13, v48, s[80:81]
    v_cndmask_b32 v12, v10, v12, s[66:67]
    v_cndmask_b32 v13, v13, v52, s[82:83]
    v_max_f32 v8, v8, v12
    ds_write_b32 v15, v13 offset:0
    v_mfma_f32_16x16x32_bf16 v[40:43], v[168:171], v[16:19], 0
    v_mfma_f32_16x16x32_bf16 v[44:47], v[172:175], v[16:19], 0
    v_mfma_f32_16x16x32_bf16 v[48:51], v[176:179], v[16:19], 0
    v_mfma_f32_16x16x32_bf16 v[52:55], v[180:183], v[16:19], 0
    s_bfe_u32 s6, s76, 0x20009
    s_lshl_b32 s6, s6, 2
    s_lshl_b64 s[66:67], s[68:69], s6
    s_add_u32 s76, s76, 32
    s_nop 0
    v_mov_b32_dpp v40, v40 quad_perm:[0,0,0,0] row_mask:0xf bank_mask:0xf
    v_mov_b32_dpp v44, v44 quad_perm:[0,0,0,0] row_mask:0xf bank_mask:0xf
    v_mov_b32_dpp v48, v48 quad_perm:[0,0,0,0] row_mask:0xf bank_mask:0xf
    v_mov_b32_dpp v52, v52 quad_perm:[0,0,0,0] row_mask:0xf bank_mask:0xf
    v_add_f32_dpp v40, v41, v40 quad_perm:[1,1,1,1] row_mask:0xf bank_mask:0xf
    v_add_f32_dpp v44, v45, v44 quad_perm:[1,1,1,1] row_mask:0xf bank_mask:0xf
    v_add_f32_dpp v48, v49, v48 quad_perm:[1,1,1,1] row_mask:0xf bank_mask:0xf
    v_add_f32_dpp v52, v53, v52 quad_perm:[1,1,1,1] row_mask:0xf bank_mask:0xf
    v_add_f32_dpp v40, v42, v40 quad_perm:[2,2,2,2] row_mask:0xf bank_mask:0xf
    v_add_f32_dpp v44, v46, v44 quad_perm:[2,2,2,2] row_mask:0xf bank_mask:0xf
    v_add_f32_dpp v48, v50, v48 quad_perm:[2,2,2,2] row_mask:0xf bank_mask:0xf
    v_add_f32_dpp v52, v54, v52 quad_perm:[2,2,2,2] row_mask:0xf bank_mask:0xf
    v_add_f32_dpp v40, v43, v40 quad_perm:[3,3,3,3] row_mask:0xf bank_mask:0xf
    v_add_f32_dpp v44, v47, v44 quad_perm:[3,3,3,3] row_mask:0xf bank_mask:0xf
    v_add_f32_dpp v48, v51, v48 quad_perm:[3,3,3,3] row_mask:0xf bank_mask:0xf
    v_add_f32_dpp v52, v55, v52 quad_perm:[3,3,3,3] row_mask:0xf bank_mask:0xf
    v_max3_f32 v12, v40, v44, v48
    v_cndmask_b32 v14, v40, v44, s[78:79]
    v_max_f32 v12, v12, v52
    v_cndmask_b32 v14, v14, v48, s[80:81]
    v_cndmask_b32 v12, v10, v12, s[66:67]
    v_cndmask_b32 v14, v14, v52, s[82:83]
    v_max_f32 v8, v8, v12
    ds_write_b32 v15, v14 offset:256
    v_add_u32 v15, 512, v15
    v_mfma_f32_16x16x32_bf16 v[40:43], v[184:187], v[16:19], 0
    v_mfma_f32_16x16x32_bf16 v[44:47], v[188:191], v[16:19], 0
    v_mfma_f32_16x16x32_bf16 v[48:51], v[192:195], v[16:19], 0
    v_mfma_f32_16x16x32_bf16 v[52:55], v[196:199], v[16:19], 0
    s_bfe_u32 s6, s76, 0x20009
    s_lshl_b32 s6, s6, 2
    s_lshl_b64 s[66:67], s[68:69], s6
    s_add_u32 s76, s76, 32
    s_nop 0
    v_mov_b32_dpp v40, v40 quad_perm:[0,0,0,0] row_mask:0xf bank_mask:0xf
    v_mov_b32_dpp v44, v44 quad_perm:[0,0,0,0] row_mask:0xf bank_mask:0xf
    v_mov_b32_dpp v48, v48 quad_perm:[0,0,0,0] row_mask:0xf bank_mask:0xf
    v_mov_b32_dpp v52, v52 quad_perm:[0,0,0,0] row_mask:0xf bank_mask:0xf
    v_add_f32_dpp v40, v41, v40 quad_perm:[1,1,1,1] row_mask:0xf bank_mask:0xf
    v_add_f32_dpp v44, v45, v44 quad_perm:[1,1,1,1] row_mask:0xf bank_mask:0xf
    v_add_f32_dpp v48, v49, v48 quad_perm:[1,1,1,1] row_mask:0xf bank_mask:0xf
    v_add_f32_dpp v52, v53, v52 quad_perm:[1,1,1,1] row_mask:0xf bank_mask:0xf
    v_add_f32_dpp v40, v42, v40 quad_perm:[2,2,2,2] row_mask:0xf bank_mask:0xf
    v_add_f32_dpp v44, v46, v44 quad_perm:[2,2,2,2] row_mask:0xf bank_mask:0xf
    v_add_f32_dpp v48, v50, v48 quad_perm:[2,2,2,2] row_mask:0xf bank_mask:0xf
    v_add_f32_dpp v52, v54, v52 quad_perm:[2,2,2,2] row_mask:0xf bank_mask:0xf
    v_add_f32_dpp v40, v43, v40 quad_perm:[3,3,3,3] row_mask:0xf bank_mask:0xf
    v_add_f32_dpp v44, v47, v44 quad_perm:[3,3,3,3] row_mask:0xf bank_mask:0xf
    v_add_f32_dpp v48, v51, v48 quad_perm:[3,3,3,3] row_mask:0xf bank_mask:0xf
    v_add_f32_dpp v52, v55, v52 quad_perm:[3,3,3,3] row_mask:0xf bank_mask:0xf
    v_max3_f32 v12, v40, v44, v48
    v_cndmask_b32 v13, v40, v44, s[78:79]
    v_max_f32 v12, v12, v52
    v_cndmask_b32 v13, v13, v48, s[80:81]
    v_cndmask_b32 v12, v10, v12, s[66:67]
    v_cndmask_b32 v13, v13, v52, s[82:83]
    v_max_f32 v8, v8, v12
    ds_write_b32 v15, v13 offset:0
    v_mfma_f32_16x16x32_bf16 v[40:43], v[200:203], v[16:19], 0
    v_mfma_f32_16x16x32_bf16 v[44:47], v[204:207], v[16:19], 0
    v_mfma_f32_16x16x32_bf16 v[48:51], v[208:211], v[16:19], 0
    v_mfma_f32_16x16x32_bf16 v[52:55], v[212:215], v[16:19], 0
    s_bfe_u32 s6, s76, 0x20009
    s_lshl_b32 s6, s6, 2
    s_lshl_b64 s[66:67], s[68:69], s6
    s_add_u32 s76, s76, 32
    s_nop 0
    v_mov_b32_dpp v40, v40 quad_perm:[0,0,0,0] row_mask:0xf bank_mask:0xf
    v_mov_b32_dpp v44, v44 quad_perm:[0,0,0,0] row_mask:0xf bank_mask:0xf
    v_mov_b32_dpp v48, v48 quad_perm:[0,0,0,0] row_mask:0xf bank_mask:0xf
    v_mov_b32_dpp v52, v52 quad_perm:[0,0,0,0] row_mask:0xf bank_mask:0xf
    v_add_f32_dpp v40, v41, v40 quad_perm:[1,1,1,1] row_mask:0xf bank_mask:0xf
    v_add_f32_dpp v44, v45, v44 quad_perm:[1,1,1,1] row_mask:0xf bank_mask:0xf
    v_add_f32_dpp v48, v49, v48 quad_perm:[1,1,1,1] row_mask:0xf bank_mask:0xf
    v_add_f32_dpp v52, v53, v52 quad_perm:[1,1,1,1] row_mask:0xf bank_mask:0xf
    v_add_f32_dpp v40, v42, v40 quad_perm:[2,2,2,2] row_mask:0xf bank_mask:0xf
    v_add_f32_dpp v44, v46, v44 quad_perm:[2,2,2,2] row_mask:0xf bank_mask:0xf
    v_add_f32_dpp v48, v50, v48 quad_perm:[2,2,2,2] row_mask:0xf bank_mask:0xf
    v_add_f32_dpp v52, v54, v52 quad_perm:[2,2,2,2] row_mask:0xf bank_mask:0xf
    v_add_f32_dpp v40, v43, v40 quad_perm:[3,3,3,3] row_mask:0xf bank_mask:0xf
    v_add_f32_dpp v44, v47, v44 quad_perm:[3,3,3,3] row_mask:0xf bank_mask:0xf
    v_add_f32_dpp v48, v51, v48 quad_perm:[3,3,3,3] row_mask:0xf bank_mask:0xf
    v_add_f32_dpp v52, v55, v52 quad_perm:[3,3,3,3] row_mask:0xf bank_mask:0xf
    v_max3_f32 v12, v40, v44, v48
    v_cndmask_b32 v14, v40, v44, s[78:79]
    v_max_f32 v12, v12, v52
    v_cndmask_b32 v14, v14, v48, s[80:81]
    v_cndmask_b32 v12, v10, v12, s[66:67]
    v_cndmask_b32 v14, v14, v52, s[82:83]
    v_max_f32 v8, v8, v12
    ds_write_b32 v15, v14 offset:256
    v_add_u32 v15, 512, v15
    s_waitcnt vmcnt(8)
    v_mfma_f32_16x16x32_bf16 v[40:43], v[216:219], v[16:19], 0
    v_mfma_f32_16x16x32_bf16 v[44:47], v[220:223], v[16:19], 0
    v_mfma_f32_16x16x32_bf16 v[48:51], v[224:227], v[16:19], 0
    v_mfma_f32_16x16x32_bf16 v[52:55], v[228:231], v[16:19], 0
    s_bfe_u32 s6, s76, 0x20009
    s_lshl_b32 s6, s6, 2
    s_lshl_b64 s[66:67], s[68:69], s6
    s_add_u32 s76, s76, 32
    s_nop 0
    v_mov_b32_dpp v40, v40 quad_perm:[0,0,0,0] row_mask:0xf bank_mask:0xf
    v_mov_b32_dpp v44, v44 quad_perm:[0,0,0,0] row_mask:0xf bank_mask:0xf
    v_mov_b32_dpp v48, v48 quad_perm:[0,0,0,0] row_mask:0xf bank_mask:0xf
    v_mov_b32_dpp v52, v52 quad_perm:[0,0,0,0] row_mask:0xf bank_mask:0xf
    v_add_f32_dpp v40, v41, v40 quad_perm:[1,1,1,1] row_mask:0xf bank_mask:0xf
    v_add_f32_dpp v44, v45, v44 quad_perm:[1,1,1,1] row_mask:0xf bank_mask:0xf
    v_add_f32_dpp v48, v49, v48 quad_perm:[1,1,1,1] row_mask:0xf bank_mask:0xf
    v_add_f32_dpp v52, v53, v52 quad_perm:[1,1,1,1] row_mask:0xf bank_mask:0xf
    v_add_f32_dpp v40, v42, v40 quad_perm:[2,2,2,2] row_mask:0xf bank_mask:0xf
    v_add_f32_dpp v44, v46, v44 quad_perm:[2,2,2,2] row_mask:0xf bank_mask:0xf
    v_add_f32_dpp v48, v50, v48 quad_perm:[2,2,2,2] row_mask:0xf bank_mask:0xf
    v_add_f32_dpp v52, v54, v52 quad_perm:[2,2,2,2] row_mask:0xf bank_mask:0xf
    v_add_f32_dpp v40, v43, v40 quad_perm:[3,3,3,3] row_mask:0xf bank_mask:0xf
    v_add_f32_dpp v44, v47, v44 quad_perm:[3,3,3,3] row_mask:0xf bank_mask:0xf
    v_add_f32_dpp v48, v51, v48 quad_perm:[3,3,3,3] row_mask:0xf bank_mask:0xf
    v_add_f32_dpp v52, v55, v52 quad_perm:[3,3,3,3] row_mask:0xf bank_mask:0xf
    v_max3_f32 v12, v40, v44, v48
    v_cndmask_b32 v13, v40, v44, s[78:79]
    v_max_f32 v12, v12, v52
    v_cndmask_b32 v13, v13, v48, s[80:81]
    v_cndmask_b32 v12, v10, v12, s[66:67]
    v_cndmask_b32 v13, v13, v52, s[82:83]
    v_max_f32 v8, v8, v12
    ds_write_b32 v15, v13 offset:0
    v_mfma_f32_16x16x32_bf16 v[40:43], v[232:235], v[16:19], 0
    v_mfma_f32_16x16x32_bf16 v[44:47], v[236:239], v[16:19], 0
    v_mfma_f32_16x16x32_bf16 v[48:51], v[240:243], v[16:19], 0
    v_mfma_f32_16x16x32_bf16 v[52:55], v[244:247], v[16:19], 0
    s_bfe_u32 s6, s76, 0x20009
    s_lshl_b32 s6, s6, 2
    s_lshl_b64 s[66:67], s[68:69], s6
    s_add_u32 s76, s76, 32
    s_nop 0
    v_mov_b32_dpp v40, v40 quad_perm:[0,0,0,0] row_mask:0xf bank_mask:0xf
    v_mov_b32_dpp v44, v44 quad_perm:[0,0,0,0] row_mask:0xf bank_mask:0xf
    v_mov_b32_dpp v48, v48 quad_perm:[0,0,0,0] row_mask:0xf bank_mask:0xf
    v_mov_b32_dpp v52, v52 quad_perm:[0,0,0,0] row_mask:0xf bank_mask:0xf
    v_add_f32_dpp v40, v41, v40 quad_perm:[1,1,1,1] row_mask:0xf bank_mask:0xf
    v_add_f32_dpp v44, v45, v44 quad_perm:[1,1,1,1] row_mask:0xf bank_mask:0xf
    v_add_f32_dpp v48, v49, v48 quad_perm:[1,1,1,1] row_mask:0xf bank_mask:0xf
    v_add_f32_dpp v52, v53, v52 quad_perm:[1,1,1,1] row_mask:0xf bank_mask:0xf
    v_add_f32_dpp v40, v42, v40 quad_perm:[2,2,2,2] row_mask:0xf bank_mask:0xf
    v_add_f32_dpp v44, v46, v44 quad_perm:[2,2,2,2] row_mask:0xf bank_mask:0xf
    v_add_f32_dpp v48, v50, v48 quad_perm:[2,2,2,2] row_mask:0xf bank_mask:0xf
    v_add_f32_dpp v52, v54, v52 quad_perm:[2,2,2,2] row_mask:0xf bank_mask:0xf
    v_add_f32_dpp v40, v43, v40 quad_perm:[3,3,3,3] row_mask:0xf bank_mask:0xf
    v_add_f32_dpp v44, v47, v44 quad_perm:[3,3,3,3] row_mask:0xf bank_mask:0xf
    v_add_f32_dpp v48, v51, v48 quad_perm:[3,3,3,3] row_mask:0xf bank_mask:0xf
    v_add_f32_dpp v52, v55, v52 quad_perm:[3,3,3,3] row_mask:0xf bank_mask:0xf
    v_max3_f32 v12, v40, v44, v48
    v_cndmask_b32 v14, v40, v44, s[78:79]
    v_max_f32 v12, v12, v52
    v_cndmask_b32 v14, v14, v48, s[80:81]
    v_cndmask_b32 v12, v10, v12, s[66:67]
    v_cndmask_b32 v14, v14, v52, s[82:83]
    v_max_f32 v8, v8, v12
    ds_write_b32 v15, v14 offset:256
    v_add_u32 v15, 512, v15
    s_mov_b32 s71, 3
L_k1:
    s_waitcnt vmcnt(0)
    s_and_b32 s6, s62, 2047
    s_lshr_b32 s7, s6, 9
    s_lshl_b32 s7, s7, 26
    s_and_b32 s6, s6, 511
    s_lshl_b32 s6, s6, 12
    s_or_b32 s6, s6, s7
    s_or_b32 s10, s6, s63
    s_add_u32 s62, s62, 32
    s_and_b32 s6, s62, 2047
    s_lshr_b32 s7, s6, 9
    s_lshl_b32 s7, s7, 26
    s_and_b32 s6, s6, 511
    s_lshl_b32 s6, s6, 12
    s_or_b32 s6, s6, s7
    s_or_b32 s11, s6, s63
    s_add_u32 s62, s62, 32
    buffer_load_dwordx4 v[88:91], v1, s[44:47], s10 offen offset:0 nt
    buffer_load_dwordx4 v[92:95], v1, s[44:47], s10 offen offset:1024 nt
    buffer_load_dwordx4 v[96:99], v1, s[44:47], s10 offen offset:2048 nt
    buffer_load_dwordx4 v[100:103], v1, s[44:47], s10 offen offset:3072 nt
    buffer_load_dwordx4 v[104:107], v1, s[44:47], s11 offen offset:0 nt
    buffer_load_dwordx4 v[108:111], v1, s[44:47], s11 offen offset:1024 nt
    buffer_load_dwordx4 v[112:115], v1, s[44:47], s11 offen offset:2048 nt
    buffer_load_dwordx4 v[116:119], v1, s[44:47], s11 offen offset:3072 nt
    v_mfma_f32_16x16x32_bf16 v[40:43], v[56:59], v[16:19], 0
    v_mfma_f32_16x16x32_bf16 v[44:47], v[60:63], v[16:19], 0
    v_mfma_f32_16x16x32_bf16 v[48:51], v[64:67], v[16:19], 0
    v_mfma_f32_16x16x32_bf16 v[52:55], v[68:71], v[16:19], 0
    s_bfe_u32 s6, s76, 0x20009
    s_lshl_b32 s6, s6, 2
    s_lshl_b64 s[66:67], s[68:69], s6
    s_add_u32 s76, s76, 32
    s_nop 0
    v_mov_b32_dpp v40, v40 quad_perm:[0,0,0,0] row_mask:0xf bank_mask:0xf
    v_mov_b32_dpp v44, v44 quad_perm:[0,0,0,0] row_mask:0xf bank_mask:0xf
    v_mov_b32_dpp v48, v48 quad_perm:[0,0,0,0] row_mask:0xf bank_mask:0xf
    v_mov_b32_dpp v52, v52 quad_perm:[0,0,0,0] row_mask:0xf bank_mask:0xf
    v_add_f32_dpp v40, v41, v40 quad_perm:[1,1,1,1] row_mask:0xf bank_mask:0xf
    v_add_f32_dpp v44, v45, v44 quad_perm:[1,1,1,1] row_mask:0xf bank_mask:0xf
    v_add_f32_dpp v48, v49, v48 quad_perm:[1,1,1,1] row_mask:0xf bank_mask:0xf
    v_add_f32_dpp v52, v53, v52 quad_perm:[1,1,1,1] row_mask:0xf bank_mask:0xf
    v_add_f32_dpp v40, v42, v40 quad_perm:[2,2,2,2] row_mask:0xf bank_mask:0xf
    v_add_f32_dpp v44, v46, v44 quad_perm:[2,2,2,2] row_mask:0xf bank_mask:0xf
    v_add_f32_dpp v48, v50, v48 quad_perm:[2,2,2,2] row_mask:0xf bank_mask:0xf
    v_add_f32_dpp v52, v54, v52 quad_perm:[2,2,2,2] row_mask:0xf bank_mask:0xf
    v_add_f32_dpp v40, v43, v40 quad_perm:[3,3,3,3] row_mask:0xf bank_mask:0xf
    v_add_f32_dpp v44, v47, v44 quad_perm:[3,3,3,3] row_mask:0xf bank_mask:0xf
    v_add_f32_dpp v48, v51, v48 quad_perm:[3,3,3,3] row_mask:0xf bank_mask:0xf
    v_add_f32_dpp v52, v55, v52 quad_perm:[3,3,3,3] row_mask:0xf bank_mask:0xf
    v_max3_f32 v12, v40, v44, v48
    v_cndmask_b32 v13, v40, v44, s[78:79]
    v_max_f32 v12, v12, v52
    v_cndmask_b32 v13, v13, v48, s[80:81]
    v_cndmask_b32 v12, v10, v12, s[66:67]
    v_cndmask_b32 v13, v13, v52, s[82:83]
    v_max_f32 v8, v8, v12
    ds_write_b32 v15, v13 offset:0
    v_mfma_f32_16x16x32_bf16 v[40:43], v[72:75], v[16:19], 0
    v_mfma_f32_16x16x32_bf16 v[44:47], v[76:79], v[16:19], 0
    v_mfma_f32_16x16x32_bf16 v[48:51], v[80:83], v[16:19], 0
    v_mfma_f32_16x16x32_bf16 v[52:55], v[84:87], v[16:19], 0
    s_bfe_u32 s6, s76, 0x20009
    s_lshl_b32 s6, s6, 2
    s_lshl_b64 s[66:67], s[68:69], s6
    s_add_u32 s76, s76, 32
    s_nop 0
    v_mov_b32_dpp v40, v40 quad_perm:[0,0,0,0] row_mask:0xf bank_mask:0xf
    v_mov_b32_dpp v44, v44 quad_perm:[0,0,0,0] row_mask:0xf bank_mask:0xf
    v_mov_b32_dpp v48, v48 quad_perm:[0,0,0,0] row_mask:0xf bank_mask:0xf
    v_mov_b32_dpp v52, v52 quad_perm:[0,0,0,0] row_mask:0xf bank_mask:0xf
    v_add_f32_dpp v40, v41, v40 quad_perm:[1,1,1,1] row_mask:0xf bank_mask:0xf
    v_add_f32_dpp v44, v45, v44 quad_perm:[1,1,1,1] row_mask:0xf bank_mask:0xf
    v_add_f32_dpp v48, v49, v48 quad_perm:[1,1,1,1] row_mask:0xf bank_mask:0xf
    v_add_f32_dpp v52, v53, v52 quad_perm:[1,1,1,1] row_mask:0xf bank_mask:0xf
    v_add_f32_dpp v40, v42, v40 quad_perm:[2,2,2,2] row_mask:0xf bank_mask:0xf
    v_add_f32_dpp v44, v46, v44 quad_perm:[2,2,2,2] row_mask:0xf bank_mask:0xf
    v_add_f32_dpp v48, v50, v48 quad_perm:[2,2,2,2] row_mask:0xf bank_mask:0xf
    v_add_f32_dpp v52, v54, v52 quad_perm:[2,2,2,2] row_mask:0xf bank_mask:0xf
    v_add_f32_dpp v40, v43, v40 quad_perm:[3,3,3,3] row_mask:0xf bank_mask:0xf
    v_add_f32_dpp v44, v47, v44 quad_perm:[3,3,3,3] row_mask:0xf bank_mask:0xf
    v_add_f32_dpp v48, v51, v48 quad_perm:[3,3,3,3] row_mask:0xf bank_mask:0xf
    v_add_f32_dpp v52, v55, v52 quad_perm:[3,3,3,3] row_mask:0xf bank_mask:0xf
    v_max3_f32 v12, v40, v44, v48
    v_cndmask_b32 v14, v40, v44, s[78:79]
    v_max_f32 v12, v12, v52
    v_cndmask_b32 v14, v14, v48, s[80:81]
    v_cndmask_b32 v12, v10, v12, s[66:67]
    v_cndmask_b32 v14, v14, v52, s[82:83]
    v_max_f32 v8, v8, v12
    ds_write_b32 v15, v14 offset:256
    v_add_u32 v15, 512, v15
    s_waitcnt vmcnt(0)
    s_and_b32 s6, s62, 2047
    s_lshr_b32 s7, s6, 9
    s_lshl_b32 s7, s7, 26
    s_and_b32 s6, s6, 511
    s_lshl_b32 s6, s6, 12
    s_or_b32 s6, s6, s7
    s_or_b32 s10, s6, s63
    s_add_u32 s62, s62, 32
    s_and_b32 s6, s62, 2047
    s_lshr_b32 s7, s6, 9
    s_lshl_b32 s7, s7, 26
    s_and_b32 s6, s6, 511
    s_lshl_b32 s6, s6, 12
    s_or_b32 s6, s6, s7
    s_or_b32 s11, s6, s63
    s_add_u32 s62, s62, 32
    buffer_load_dwordx4 v[56:59], v1, s[44:47], s10 offen offset:0 nt
    buffer_load_dwordx4 v[60:63], v1, s[44:47], s10 offen offset:1024 nt
    buffer_load_dwordx4 v[64:67], v1, s[44:47], s10 offen offset:2048 nt
    buffer_load_dwordx4 v[68:71], v1, s[44:47], s10 offen offset:3072 nt
    buffer_load_dwordx4 v[72:75], v1, s[44:47], s11 offen offset:0 nt
    buffer_load_dwordx4 v[76:79], v1, s[44:47], s11 offen offset:1024 nt
    buffer_load_dwordx4 v[80:83], v1, s[44:47], s11 offen offset:2048 nt
    buffer_load_dwordx4 v[84:87], v1, s[44:47], s11 offen offset:3072 nt
    v_mfma_f32_16x16x32_bf16 v[40:43], v[88:91], v[16:19], 0
    v_mfma_f32_16x16x32_bf16 v[44:47], v[92:95], v[16:19], 0
    v_mfma_f32_16x16x32_bf16 v[48:51], v[96:99], v[16:19], 0
    v_mfma_f32_16x16x32_bf16 v[52:55], v[100:103], v[16:19], 0
    s_bfe_u32 s6, s76, 0x20009
    s_lshl_b32 s6, s6, 2
    s_lshl_b64 s[66:67], s[68:69], s6
    s_add_u32 s76, s76, 32
    s_nop 0
    v_mov_b32_dpp v40, v40 quad_perm:[0,0,0,0] row_mask:0xf bank_mask:0xf
    v_mov_b32_dpp v44, v44 quad_perm:[0,0,0,0] row_mask:0xf bank_mask:0xf
    v_mov_b32_dpp v48, v48 quad_perm:[0,0,0,0] row_mask:0xf bank_mask:0xf
    v_mov_b32_dpp v52, v52 quad_perm:[0,0,0,0] row_mask:0xf bank_mask:0xf
    v_add_f32_dpp v40, v41, v40 quad_perm:[1,1,1,1] row_mask:0xf bank_mask:0xf
    v_add_f32_dpp v44, v45, v44 quad_perm:[1,1,1,1] row_mask:0xf bank_mask:0xf
    v_add_f32_dpp v48, v49, v48 quad_perm:[1,1,1,1] row_mask:0xf bank_mask:0xf
    v_add_f32_dpp v52, v53, v52 quad_perm:[1,1,1,1] row_mask:0xf bank_mask:0xf
    v_add_f32_dpp v40, v42, v40 quad_perm:[2,2,2,2] row_mask:0xf bank_mask:0xf
    v_add_f32_dpp v44, v46, v44 quad_perm:[2,2,2,2] row_mask:0xf bank_mask:0xf
    v_add_f32_dpp v48, v50, v48 quad_perm:[2,2,2,2] row_mask:0xf bank_mask:0xf
    v_add_f32_dpp v52, v54, v52 quad_perm:[2,2,2,2] row_mask:0xf bank_mask:0xf
    v_add_f32_dpp v40, v43, v40 quad_perm:[3,3,3,3] row_mask:0xf bank_mask:0xf
    v_add_f32_dpp v44, v47, v44 quad_perm:[3,3,3,3] row_mask:0xf bank_mask:0xf
    v_add_f32_dpp v48, v51, v48 quad_perm:[3,3,3,3] row_mask:0xf bank_mask:0xf
    v_add_f32_dpp v52, v55, v52 quad_perm:[3,3,3,3] row_mask:0xf bank_mask:0xf
    v_max3_f32 v12, v40, v44, v48
    v_cndmask_b32 v13, v40, v44, s[78:79]
    v_max_f32 v12, v12, v52
    v_cndmask_b32 v13, v13, v48, s[80:81]
    v_cndmask_b32 v12, v10, v12, s[66:67]
    v_cndmask_b32 v13, v13, v52, s[82:83]
    v_max_f32 v8, v8, v12
    ds_write_b32 v15, v13 offset:0
    v_mfma_f32_16x16x32_bf16 v[40:43], v[104:107], v[16:19], 0
    v_mfma_f32_16x16x32_bf16 v[44:47], v[108:111], v[16:19], 0
    v_mfma_f32_16x16x32_bf16 v[48:51], v[112:115], v[16:19], 0
    v_mfma_f32_16x16x32_bf16 v[52:55], v[116:119], v[16:19], 0
    s_bfe_u32 s6, s76, 0x20009
    s_lshl_b32 s6, s6, 2
    s_lshl_b64 s[66:67], s[68:69], s6
    s_add_u32 s76, s76, 32
    s_nop 0
    v_mov_b32_dpp v40, v40 quad_perm:[0,0,0,0] row_mask:0xf bank_mask:0xf
    v_mov_b32_dpp v44, v44 quad_perm:[0,0,0,0] row_mask:0xf bank_mask:0xf
    v_mov_b32_dpp v48, v48 quad_perm:[0,0,0,0] row_mask:0xf bank_mask:0xf
    v_mov_b32_dpp v52, v52 quad_perm:[0,0,0,0] row_mask:0xf bank_mask:0xf
    v_add_f32_dpp v40, v41, v40 quad_perm:[1,1,1,1] row_mask:0xf bank_mask:0xf
    v_add_f32_dpp v44, v45, v44 quad_perm:[1,1,1,1] row_mask:0xf bank_mask:0xf
    v_add_f32_dpp v48, v49, v48 quad_perm:[1,1,1,1] row_mask:0xf bank_mask:0xf
    v_add_f32_dpp v52, v53, v52 quad_perm:[1,1,1,1] row_mask:0xf bank_mask:0xf
    v_add_f32_dpp v40, v42, v40 quad_perm:[2,2,2,2] row_mask:0xf bank_mask:0xf
    v_add_f32_dpp v44, v46, v44 quad_perm:[2,2,2,2] row_mask:0xf bank_mask:0xf
    v_add_f32_dpp v48, v50, v48 quad_perm:[2,2,2,2] row_mask:0xf bank_mask:0xf
    v_add_f32_dpp v52, v54, v52 quad_perm:[2,2,2,2] row_mask:0xf bank_mask:0xf
    v_add_f32_dpp v40, v43, v40 quad_perm:[3,3,3,3] row_mask:0xf bank_mask:0xf
    v_add_f32_dpp v44, v47, v44 quad_perm:[3,3,3,3] row_mask:0xf bank_mask:0xf
    v_add_f32_dpp v48, v51, v48 quad_perm:[3,3,3,3] row_mask:0xf bank_mask:0xf
    v_add_f32_dpp v52, v55, v52 quad_perm:[3,3,3,3] row_mask:0xf bank_mask:0xf
    v_max3_f32 v12, v40, v44, v48
    v_cndmask_b32 v14, v40, v44, s[78:79]
    v_max_f32 v12, v12, v52
    v_cndmask_b32 v14, v14, v48, s[80:81]
    v_cndmask_b32 v12, v10, v12, s[66:67]
    v_cndmask_b32 v14, v14, v52, s[82:83]
    v_max_f32 v8, v8, v12
    ds_write_b32 v15, v14 offset:256
    v_add_u32 v15, 512, v15
    s_sub_u32 s71, s71, 1
    s_cmp_lg_u32 s71, 0
    s_cbranch_scc1 L_k1
    s_and_b32 s6, s4, 7
    s_cmp_eq_u32 s6, s5
    s_cbranch_scc1 L_phaseA
    s_cmp_gt_u32 s5, s6
    s_cselect_b32 s6, 4, 0
    s_add_u32 s9, s8, 832
    s_sub_u32 s9, s9, s6
    s_mov_b32 s62, s9
    s_waitcnt vmcnt(0)
    s_and_b32 s6, s62, 2047
    s_lshr_b32 s7, s6, 9
    s_lshl_b32 s7, s7, 26
    s_and_b32 s6, s6, 511
    s_lshl_b32 s6, s6, 12
    s_or_b32 s6, s6, s7
    s_or_b32 s10, s6, s63
    s_add_u32 s62, s62, 28
    s_and_b32 s6, s62, 2047
    s_lshr_b32 s7, s6, 9
    s_lshl_b32 s7, s7, 26
    s_and_b32 s6, s6, 511
    s_lshl_b32 s6, s6, 12
    s_or_b32 s6, s6, s7
    s_or_b32 s11, s6, s63
    s_add_u32 s62, s62, 28
    buffer_load_dwordx4 v[88:91], v1, s[44:47], s10 offen offset:0 nt
    buffer_load_dwordx4 v[92:95], v1, s[44:47], s10 offen offset:1024 nt
    buffer_load_dwordx4 v[96:99], v1, s[44:47], s10 offen offset:2048 nt
    buffer_load_dwordx4 v[100:103], v1, s[44:47], s10 offen offset:3072 nt
    buffer_load_dwordx4 v[104:107], v1, s[44:47], s11 offen offset:0 nt
    buffer_load_dwordx4 v[108:111], v1, s[44:47], s11 offen offset:1024 nt
    buffer_load_dwordx4 v[112:115], v1, s[44:47], s11 offen offset:2048 nt
    buffer_load_dwordx4 v[116:119], v1, s[44:47], s11 offen offset:3072 nt
    v_mfma_f32_16x16x32_bf16 v[40:43], v[56:59], v[16:19], 0
    v_mfma_f32_16x16x32_bf16 v[44:47], v[60:63], v[16:19], 0
    v_mfma_f32_16x16x32_bf16 v[48:51], v[64:67], v[16:19], 0
    v_mfma_f32_16x16x32_bf16 v[52:55], v[68:71], v[16:19], 0
    s_bfe_u32 s6, s76, 0x20009
    s_lshl_b32 s6, s6, 2
    s_lshl_b64 s[66:67], s[68:69], s6
    s_add_u32 s76, s76, 32
    s_nop 0
    v_mov_b32_dpp v40, v40 quad_perm:[0,0,0,0] row_mask:0xf bank_mask:0xf
    v_mov_b32_dpp v44, v44 quad_perm:[0,0,0,0] row_mask:0xf bank_mask:0xf
    v_mov_b32_dpp v48, v48 quad_perm:[0,0,0,0] row_mask:0xf bank_mask:0xf
    v_mov_b32_dpp v52, v52 quad_perm:[0,0,0,0] row_mask:0xf bank_mask:0xf
    v_add_f32_dpp v40, v41, v40 quad_perm:[1,1,1,1] row_mask:0xf bank_mask:0xf
    v_add_f32_dpp v44, v45, v44 quad_perm:[1,1,1,1] row_mask:0xf bank_mask:0xf
    v_add_f32_dpp v48, v49, v48 quad_perm:[1,1,1,1] row_mask:0xf bank_mask:0xf
    v_add_f32_dpp v52, v53, v52 quad_perm:[1,1,1,1] row_mask:0xf bank_mask:0xf
    v_add_f32_dpp v40, v42, v40 quad_perm:[2,2,2,2] row_mask:0xf bank_mask:0xf
    v_add_f32_dpp v44, v46, v44 quad_perm:[2,2,2,2] row_mask:0xf bank_mask:0xf
    v_add_f32_dpp v48, v50, v48 quad_perm:[2,2,2,2] row_mask:0xf bank_mask:0xf
    v_add_f32_dpp v52, v54, v52 quad_perm:[2,2,2,2] row_mask:0xf bank_mask:0xf
    v_add_f32_dpp v40, v43, v40 quad_perm:[3,3,3,3] row_mask:0xf bank_mask:0xf
    v_add_f32_dpp v44, v47, v44 quad_perm:[3,3,3,3] row_mask:0xf bank_mask:0xf
    v_add_f32_dpp v48, v51, v48 quad_perm:[3,3,3,3] row_mask:0xf bank_mask:0xf
    v_add_f32_dpp v52, v55, v52 quad_perm:[3,3,3,3] row_mask:0xf bank_mask:0xf
    v_max3_f32 v12, v40, v44, v48
    v_cndmask_b32 v13, v40, v44, s[78:79]
    v_max_f32 v12, v12, v52
    v_cndmask_b32 v13, v13, v48, s[80:81]
    v_cndmask_b32 v12, v10, v12, s[66:67]
    v_cndmask_b32 v13, v13, v52, s[82:83]
    v_max_f32 v8, v8, v12
    ds_write_b32 v15, v13 offset:0
    v_mfma_f32_16x16x32_bf16 v[40:43], v[72:75], v[16:19], 0
    v_mfma_f32_16x16x32_bf16 v[44:47], v[76:79], v[16:19], 0
    v_mfma_f32_16x16x32_bf16 v[48:51], v[80:83], v[16:19], 0
    v_mfma_f32_16x16x32_bf16 v[52:55], v[84:87], v[16:19], 0
    s_bfe_u32 s6, s76, 0x20009
    s_lshl_b32 s6, s6, 2
    s_lshl_b64 s[66:67], s[68:69], s6
    s_add_u32 s76, s76, 32
    s_nop 0
    v_mov_b32_dpp v40, v40 quad_perm:[0,0,0,0] row_mask:0xf bank_mask:0xf
    v_mov_b32_dpp v44, v44 quad_perm:[0,0,0,0] row_mask:0xf bank_mask:0xf
    v_mov_b32_dpp v48, v48 quad_perm:[0,0,0,0] row_mask:0xf bank_mask:0xf
    v_mov_b32_dpp v52, v52 quad_perm:[0,0,0,0] row_mask:0xf bank_mask:0xf
    v_add_f32_dpp v40, v41, v40 quad_perm:[1,1,1,1] row_mask:0xf bank_mask:0xf
    v_add_f32_dpp v44, v45, v44 quad_perm:[1,1,1,1] row_mask:0xf bank_mask:0xf
    v_add_f32_dpp v48, v49, v48 quad_perm:[1,1,1,1] row_mask:0xf bank_mask:0xf
    v_add_f32_dpp v52, v53, v52 quad_perm:[1,1,1,1] row_mask:0xf bank_mask:0xf
    v_add_f32_dpp v40, v42, v40 quad_perm:[2,2,2,2] row_mask:0xf bank_mask:0xf
    v_add_f32_dpp v44, v46, v44 quad_perm:[2,2,2,2] row_mask:0xf bank_mask:0xf
    v_add_f32_dpp v48, v50, v48 quad_perm:[2,2,2,2] row_mask:0xf bank_mask:0xf
    v_add_f32_dpp v52, v54, v52 quad_perm:[2,2,2,2] row_mask:0xf bank_mask:0xf
    v_add_f32_dpp v40, v43, v40 quad_perm:[3,3,3,3] row_mask:0xf bank_mask:0xf
    v_add_f32_dpp v44, v47, v44 quad_perm:[3,3,3,3] row_mask:0xf bank_mask:0xf
    v_add_f32_dpp v48, v51, v48 quad_perm:[3,3,3,3] row_mask:0xf bank_mask:0xf
    v_add_f32_dpp v52, v55, v52 quad_perm:[3,3,3,3] row_mask:0xf bank_mask:0xf
    v_max3_f32 v12, v40, v44, v48
    v_cndmask_b32 v14, v40, v44, s[78:79]
    v_max_f32 v12, v12, v52
    v_cndmask_b32 v14, v14, v48, s[80:81]
    v_cndmask_b32 v12, v10, v12, s[66:67]
    v_cndmask_b32 v14, v14, v52, s[82:83]
    v_max_f32 v8, v8, v12
    ds_write_b32 v15, v14 offset:256
    v_add_u32 v15, 512, v15
    s_mov_b32 s76, s9
    s_waitcnt vmcnt(0)
    s_and_b32 s6, s62, 2047
    s_lshr_b32 s7, s6, 9
    s_lshl_b32 s7, s7, 26
    s_and_b32 s6, s6, 511
    s_lshl_b32 s6, s6, 12
    s_or_b32 s6, s6, s7
    s_or_b32 s10, s6, s63
    s_add_u32 s62, s62, 28
    s_and_b32 s6, s62, 2047
    s_lshr_b32 s7, s6, 9
    s_lshl_b32 s7, s7, 26
    s_and_b32 s6, s6, 511
    s_lshl_b32 s6, s6, 12
    s_or_b32 s6, s6, s7
    s_or_b32 s11, s6, s63
    s_add_u32 s62, s62, 28
    buffer_load_dwordx4 v[56:59], v1, s[44:47], s10 offen offset:0 nt
    buffer_load_dwordx4 v[60:63], v1, s[44:47], s10 offen offset:1024 nt
    buffer_load_dwordx4 v[64:67], v1, s[44:47], s10 offen offset:2048 nt
    buffer_load_dwordx4 v[68:71], v1, s[44:47], s10 offen offset:3072 nt
    buffer_load_dwordx4 v[72:75], v1, s[44:47], s11 offen offset:0 nt
    buffer_load_dwordx4 v[76:79], v1, s[44:47], s11 offen offset:1024 nt
    buffer_load_dwordx4 v[80:83], v1, s[44:47], s11 offen offset:2048 nt
    buffer_load_dwordx4 v[84:87], v1, s[44:47], s11 offen offset:3072 nt
    v_mfma_f32_16x16x32_bf16 v[40:43], v[88:91], v[16:19], 0
    v_mfma_f32_16x16x32_bf16 v[44:47], v[92:95], v[16:19], 0
    v_mfma_f32_16x16x32_bf16 v[48:51], v[96:99], v[16:19], 0
    v_mfma_f32_16x16x32_bf16 v[52:55], v[100:103], v[16:19], 0
    s_bfe_u32 s6, s76, 0x20009
    s_lshl_b32 s6, s6, 2
    s_lshl_b64 s[66:67], s[68:69], s6
    s_add_u32 s76, s76, 28
    s_nop 0
    v_mov_b32_dpp v40, v40 quad_perm:[0,0,0,0] row_mask:0xf bank_mask:0xf
    v_mov_b32_dpp v44, v44 quad_perm:[0,0,0,0] row_mask:0xf bank_mask:0xf
    v_mov_b32_dpp v48, v48 quad_perm:[0,0,0,0] row_mask:0xf bank_mask:0xf
    v_mov_b32_dpp v52, v52 quad_perm:[0,0,0,0] row_mask:0xf bank_mask:0xf
    v_add_f32_dpp v40, v41, v40 quad_perm:[1,1,1,1] row_mask:0xf bank_mask:0xf
    v_add_f32_dpp v44, v45, v44 quad_perm:[1,1,1,1] row_mask:0xf bank_mask:0xf
    v_add_f32_dpp v48, v49, v48 quad_perm:[1,1,1,1] row_mask:0xf bank_mask:0xf
    v_add_f32_dpp v52, v53, v52 quad_perm:[1,1,1,1] row_mask:0xf bank_mask:0xf
    v_add_f32_dpp v40, v42, v40 quad_perm:[2,2,2,2] row_mask:0xf bank_mask:0xf
    v_add_f32_dpp v44, v46, v44 quad_perm:[2,2,2,2] row_mask:0xf bank_mask:0xf
    v_add_f32_dpp v48, v50, v48 quad_perm:[2,2,2,2] row_mask:0xf bank_mask:0xf
    v_add_f32_dpp v52, v54, v52 quad_perm:[2,2,2,2] row_mask:0xf bank_mask:0xf
    v_add_f32_dpp v40, v43, v40 quad_perm:[3,3,3,3] row_mask:0xf bank_mask:0xf
    v_add_f32_dpp v44, v47, v44 quad_perm:[3,3,3,3] row_mask:0xf bank_mask:0xf
    v_add_f32_dpp v48, v51, v48 quad_perm:[3,3,3,3] row_mask:0xf bank_mask:0xf
    v_add_f32_dpp v52, v55, v52 quad_perm:[3,3,3,3] row_mask:0xf bank_mask:0xf
    v_max3_f32 v12, v40, v44, v48
    v_cndmask_b32 v13, v40, v44, s[78:79]
    v_max_f32 v12, v12, v52
    v_cndmask_b32 v13, v13, v48, s[80:81]
    v_cndmask_b32 v12, v10, v12, s[66:67]
    v_cndmask_b32 v13, v13, v52, s[82:83]
    v_max_f32 v8, v8, v12
    ds_write_b32 v15, v13 offset:0
    v_mfma_f32_16x16x32_bf16 v[40:43], v[104:107], v[16:19], 0
    v_mfma_f32_16x16x32_bf16 v[44:47], v[108:111], v[16:19], 0
    v_mfma_f32_16x16x32_bf16 v[48:51], v[112:115], v[16:19], 0
    v_mfma_f32_16x16x32_bf16 v[52:55], v[116:119], v[16:19], 0
    s_bfe_u32 s6, s76, 0x20009
    s_lshl_b32 s6, s6, 2
    s_lshl_b64 s[66:67], s[68:69], s6
    s_add_u32 s76, s76, 28
    s_nop 0
    v_mov_b32_dpp v40, v40 quad_perm:[0,0,0,0] row_mask:0xf bank_mask:0xf
    v_mov_b32_dpp v44, v44 quad_perm:[0,0,0,0] row_mask:0xf bank_mask:0xf
    v_mov_b32_dpp v48, v48 quad_perm:[0,0,0,0] row_mask:0xf bank_mask:0xf
    v_mov_b32_dpp v52, v52 quad_perm:[0,0,0,0] row_mask:0xf bank_mask:0xf
    v_add_f32_dpp v40, v41, v40 quad_perm:[1,1,1,1] row_mask:0xf bank_mask:0xf
    v_add_f32_dpp v44, v45, v44 quad_perm:[1,1,1,1] row_mask:0xf bank_mask:0xf
    v_add_f32_dpp v48, v49, v48 quad_perm:[1,1,1,1] row_mask:0xf bank_mask:0xf
    v_add_f32_dpp v52, v53, v52 quad_perm:[1,1,1,1] row_mask:0xf bank_mask:0xf
    v_add_f32_dpp v40, v42, v40 quad_perm:[2,2,2,2] row_mask:0xf bank_mask:0xf
    v_add_f32_dpp v44, v46, v44 quad_perm:[2,2,2,2] row_mask:0xf bank_mask:0xf
    v_add_f32_dpp v48, v50, v48 quad_perm:[2,2,2,2] row_mask:0xf bank_mask:0xf
    v_add_f32_dpp v52, v54, v52 quad_perm:[2,2,2,2] row_mask:0xf bank_mask:0xf
    v_add_f32_dpp v40, v43, v40 quad_perm:[3,3,3,3] row_mask:0xf bank_mask:0xf
    v_add_f32_dpp v44, v47, v44 quad_perm:[3,3,3,3] row_mask:0xf bank_mask:0xf
    v_add_f32_dpp v48, v51, v48 quad_perm:[3,3,3,3] row_mask:0xf bank_mask:0xf
    v_add_f32_dpp v52, v55, v52 quad_perm:[3,3,3,3] row_mask:0xf bank_mask:0xf
    v_max3_f32 v12, v40, v44, v48
    v_cndmask_b32 v14, v40, v44, s[78:79]
    v_max_f32 v12, v12, v52
    v_cndmask_b32 v14, v14, v48, s[80:81]
    v_cndmask_b32 v12, v10, v12, s[66:67]
    v_cndmask_b32 v14, v14, v52, s[82:83]
    v_max_f32 v8, v8, v12
    ds_write_b32 v15, v14 offset:256
    v_add_u32 v15, 512, v15
    s_mov_b32 s71, 7
L_k2:
    s_waitcnt vmcnt(0)
    s_and_b32 s6, s62, 2047
    s_lshr_b32 s7, s6, 9
    s_lshl_b32 s7, s7, 26
    s_and_b32 s6, s6, 511
    s_lshl_b32 s6, s6, 12
    s_or_b32 s6, s6, s7
    s_or_b32 s10, s6, s63
    s_add_u32 s62, s62, 28
    s_and_b32 s6, s62, 2047
    s_lshr_b32 s7, s6, 9
    s_lshl_b32 s7, s7, 26
    s_and_b32 s6, s6, 511
    s_lshl_b32 s6, s6, 12
    s_or_b32 s6, s6, s7
    s_or_b32 s11, s6, s63
    s_add_u32 s62, s62, 28
    buffer_load_dwordx4 v[88:91], v1, s[44:47], s10 offen offset:0 nt
    buffer_load_dwordx4 v[92:95], v1, s[44:47], s10 offen offset:1024 nt
    buffer_load_dwordx4 v[96:99], v1, s[44:47], s10 offen offset:2048 nt
    buffer_load_dwordx4 v[100:103], v1, s[44:47], s10 offen offset:3072 nt
    buffer_load_dwordx4 v[104:107], v1, s[44:47], s11 offen offset:0 nt
    buffer_load_dwordx4 v[108:111], v1, s[44:47], s11 offen offset:1024 nt
    buffer_load_dwordx4 v[112:115], v1, s[44:47], s11 offen offset:2048 nt
    buffer_load_dwordx4 v[116:119], v1, s[44:47], s11 offen offset:3072 nt
    v_mfma_f32_16x16x32_bf16 v[40:43], v[56:59], v[16:19], 0
    v_mfma_f32_16x16x32_bf16 v[44:47], v[60:63], v[16:19], 0
    v_mfma_f32_16x16x32_bf16 v[48:51], v[64:67], v[16:19], 0
    v_mfma_f32_16x16x32_bf16 v[52:55], v[68:71], v[16:19], 0
    s_bfe_u32 s6, s76, 0x20009
    s_lshl_b32 s6, s6, 2
    s_lshl_b64 s[66:67], s[68:69], s6
    s_add_u32 s76, s76, 28
    s_nop 0
    v_mov_b32_dpp v40, v40 quad_perm:[0,0,0,0] row_mask:0xf bank_mask:0xf
    v_mov_b32_dpp v44, v44 quad_perm:[0,0,0,0] row_mask:0xf bank_mask:0xf
    v_mov_b32_dpp v48, v48 quad_perm:[0,0,0,0] row_mask:0xf bank_mask:0xf
    v_mov_b32_dpp v52, v52 quad_perm:[0,0,0,0] row_mask:0xf bank_mask:0xf
    v_add_f32_dpp v40, v41, v40 quad_perm:[1,1,1,1] row_mask:0xf bank_mask:0xf
    v_add_f32_dpp v44, v45, v44 quad_perm:[1,1,1,1] row_mask:0xf bank_mask:0xf
    v_add_f32_dpp v48, v49, v48 quad_perm:[1,1,1,1] row_mask:0xf bank_mask:0xf
    v_add_f32_dpp v52, v53, v52 quad_perm:[1,1,1,1] row_mask:0xf bank_mask:0xf
    v_add_f32_dpp v40, v42, v40 quad_perm:[2,2,2,2] row_mask:0xf bank_mask:0xf
    v_add_f32_dpp v44, v46, v44 quad_perm:[2,2,2,2] row_mask:0xf bank_mask:0xf
    v_add_f32_dpp v48, v50, v48 quad_perm:[2,2,2,2] row_mask:0xf bank_mask:0xf
    v_add_f32_dpp v52, v54, v52 quad_perm:[2,2,2,2] row_mask:0xf bank_mask:0xf
    v_add_f32_dpp v40, v43, v40 quad_perm:[3,3,3,3] row_mask:0xf bank_mask:0xf
    v_add_f32_dpp v44, v47, v44 quad_perm:[3,3,3,3] row_mask:0xf bank_mask:0xf
    v_add_f32_dpp v48, v51, v48 quad_perm:[3,3,3,3] row_mask:0xf bank_mask:0xf
    v_add_f32_dpp v52, v55, v52 quad_perm:[3,3,3,3] row_mask:0xf bank_mask:0xf
    v_max3_f32 v12, v40, v44, v48
    v_cndmask_b32 v13, v40, v44, s[78:79]
    v_max_f32 v12, v12, v52
    v_cndmask_b32 v13, v13, v48, s[80:81]
    v_cndmask_b32 v12, v10, v12, s[66:67]
    v_cndmask_b32 v13, v13, v52, s[82:83]
    v_max_f32 v8, v8, v12
    ds_write_b32 v15, v13 offset:0
    v_mfma_f32_16x16x32_bf16 v[40:43], v[72:75], v[16:19], 0
    v_mfma_f32_16x16x32_bf16 v[44:47], v[76:79], v[16:19], 0
    v_mfma_f32_16x16x32_bf16 v[48:51], v[80:83], v[16:19], 0
    v_mfma_f32_16x16x32_bf16 v[52:55], v[84:87], v[16:19], 0
    s_bfe_u32 s6, s76, 0x20009
    s_lshl_b32 s6, s6, 2
    s_lshl_b64 s[66:67], s[68:69], s6
    s_add_u32 s76, s76, 28
    s_nop 0
    v_mov_b32_dpp v40, v40 quad_perm:[0,0,0,0] row_mask:0xf bank_mask:0xf
    v_mov_b32_dpp v44, v44 quad_perm:[0,0,0,0] row_mask:0xf bank_mask:0xf
    v_mov_b32_dpp v48, v48 quad_perm:[0,0,0,0] row_mask:0xf bank_mask:0xf
    v_mov_b32_dpp v52, v52 quad_perm:[0,0,0,0] row_mask:0xf bank_mask:0xf
    v_add_f32_dpp v40, v41, v40 quad_perm:[1,1,1,1] row_mask:0xf bank_mask:0xf
    v_add_f32_dpp v44, v45, v44 quad_perm:[1,1,1,1] row_mask:0xf bank_mask:0xf
    v_add_f32_dpp v48, v49, v48 quad_perm:[1,1,1,1] row_mask:0xf bank_mask:0xf
    v_add_f32_dpp v52, v53, v52 quad_perm:[1,1,1,1] row_mask:0xf bank_mask:0xf
    v_add_f32_dpp v40, v42, v40 quad_perm:[2,2,2,2] row_mask:0xf bank_mask:0xf
    v_add_f32_dpp v44, v46, v44 quad_perm:[2,2,2,2] row_mask:0xf bank_mask:0xf
    v_add_f32_dpp v48, v50, v48 quad_perm:[2,2,2,2] row_mask:0xf bank_mask:0xf
    v_add_f32_dpp v52, v54, v52 quad_perm:[2,2,2,2] row_mask:0xf bank_mask:0xf
    v_add_f32_dpp v40, v43, v40 quad_perm:[3,3,3,3] row_mask:0xf bank_mask:0xf
    v_add_f32_dpp v44, v47, v44 quad_perm:[3,3,3,3] row_mask:0xf bank_mask:0xf
    v_add_f32_dpp v48, v51, v48 quad_perm:[3,3,3,3] row_mask:0xf bank_mask:0xf
    v_add_f32_dpp v52, v55, v52 quad_perm:[3,3,3,3] row_mask:0xf bank_mask:0xf
    v_max3_f32 v12, v40, v44, v48
    v_cndmask_b32 v14, v40, v44, s[78:79]
    v_max_f32 v12, v12, v52
    v_cndmask_b32 v14, v14, v48, s[80:81]
    v_cndmask_b32 v12, v10, v12, s[66:67]
    v_cndmask_b32 v14, v14, v52, s[82:83]
    v_max_f32 v8, v8, v12
    ds_write_b32 v15, v14 offset:256
    v_add_u32 v15, 512, v15
    s_waitcnt vmcnt(0)
    s_and_b32 s6, s62, 2047
    s_lshr_b32 s7, s6, 9
    s_lshl_b32 s7, s7, 26
    s_and_b32 s6, s6, 511
    s_lshl_b32 s6, s6, 12
    s_or_b32 s6, s6, s7
    s_or_b32 s10, s6, s63
    s_add_u32 s62, s62, 28
    s_and_b32 s6, s62, 2047
    s_lshr_b32 s7, s6, 9
    s_lshl_b32 s7, s7, 26
    s_and_b32 s6, s6, 511
    s_lshl_b32 s6, s6, 12
    s_or_b32 s6, s6, s7
    s_or_b32 s11, s6, s63
    s_add_u32 s62, s62, 28
    buffer_load_dwordx4 v[56:59], v1, s[44:47], s10 offen offset:0 nt
    buffer_load_dwordx4 v[60:63], v1, s[44:47], s10 offen offset:1024 nt
    buffer_load_dwordx4 v[64:67], v1, s[44:47], s10 offen offset:2048 nt
    buffer_load_dwordx4 v[68:71], v1, s[44:47], s10 offen offset:3072 nt
    buffer_load_dwordx4 v[72:75], v1, s[44:47], s11 offen offset:0 nt
    buffer_load_dwordx4 v[76:79], v1, s[44:47], s11 offen offset:1024 nt
    buffer_load_dwordx4 v[80:83], v1, s[44:47], s11 offen offset:2048 nt
    buffer_load_dwordx4 v[84:87], v1, s[44:47], s11 offen offset:3072 nt
    v_mfma_f32_16x16x32_bf16 v[40:43], v[88:91], v[16:19], 0
    v_mfma_f32_16x16x32_bf16 v[44:47], v[92:95], v[16:19], 0
    v_mfma_f32_16x16x32_bf16 v[48:51], v[96:99], v[16:19], 0
    v_mfma_f32_16x16x32_bf16 v[52:55], v[100:103], v[16:19], 0
    s_bfe_u32 s6, s76, 0x20009
    s_lshl_b32 s6, s6, 2
    s_lshl_b64 s[66:67], s[68:69], s6
    s_add_u32 s76, s76, 28
    s_nop 0
    v_mov_b32_dpp v40, v40 quad_perm:[0,0,0,0] row_mask:0xf bank_mask:0xf
    v_mov_b32_dpp v44, v44 quad_perm:[0,0,0,0] row_mask:0xf bank_mask:0xf
    v_mov_b32_dpp v48, v48 quad_perm:[0,0,0,0] row_mask:0xf bank_mask:0xf
    v_mov_b32_dpp v52, v52 quad_perm:[0,0,0,0] row_mask:0xf bank_mask:0xf
    v_add_f32_dpp v40, v41, v40 quad_perm:[1,1,1,1] row_mask:0xf bank_mask:0xf
    v_add_f32_dpp v44, v45, v44 quad_perm:[1,1,1,1] row_mask:0xf bank_mask:0xf
    v_add_f32_dpp v48, v49, v48 quad_perm:[1,1,1,1] row_mask:0xf bank_mask:0xf
    v_add_f32_dpp v52, v53, v52 quad_perm:[1,1,1,1] row_mask:0xf bank_mask:0xf
    v_add_f32_dpp v40, v42, v40 quad_perm:[2,2,2,2] row_mask:0xf bank_mask:0xf
    v_add_f32_dpp v44, v46, v44 quad_perm:[2,2,2,2] row_mask:0xf bank_mask:0xf
    v_add_f32_dpp v48, v50, v48 quad_perm:[2,2,2,2] row_mask:0xf bank_mask:0xf
    v_add_f32_dpp v52, v54, v52 quad_perm:[2,2,2,2] row_mask:0xf bank_mask:0xf
    v_add_f32_dpp v40, v43, v40 quad_perm:[3,3,3,3] row_mask:0xf bank_mask:0xf
    v_add_f32_dpp v44, v47, v44 quad_perm:[3,3,3,3] row_mask:0xf bank_mask:0xf
    v_add_f32_dpp v48, v51, v48 quad_perm:[3,3,3,3] row_mask:0xf bank_mask:0xf
    v_add_f32_dpp v52, v55, v52 quad_perm:[3,3,3,3] row_mask:0xf bank_mask:0xf
    v_max3_f32 v12, v40, v44, v48
    v_cndmask_b32 v13, v40, v44, s[78:79]
    v_max_f32 v12, v12, v52
    v_cndmask_b32 v13, v13, v48, s[80:81]
    v_cndmask_b32 v12, v10, v12, s[66:67]
    v_cndmask_b32 v13, v13, v52, s[82:83]
    v_max_f32 v8, v8, v12
    ds_write_b32 v15, v13 offset:0
    v_mfma_f32_16x16x32_bf16 v[40:43], v[104:107], v[16:19], 0
    v_mfma_f32_16x16x32_bf16 v[44:47], v[108:111], v[16:19], 0
    v_mfma_f32_16x16x32_bf16 v[48:51], v[112:115], v[16:19], 0
    v_mfma_f32_16x16x32_bf16 v[52:55], v[116:119], v[16:19], 0
    s_bfe_u32 s6, s76, 0x20009
    s_lshl_b32 s6, s6, 2
    s_lshl_b64 s[66:67], s[68:69], s6
    s_add_u32 s76, s76, 28
    s_nop 0
    v_mov_b32_dpp v40, v40 quad_perm:[0,0,0,0] row_mask:0xf bank_mask:0xf
    v_mov_b32_dpp v44, v44 quad_perm:[0,0,0,0] row_mask:0xf bank_mask:0xf
    v_mov_b32_dpp v48, v48 quad_perm:[0,0,0,0] row_mask:0xf bank_mask:0xf
    v_mov_b32_dpp v52, v52 quad_perm:[0,0,0,0] row_mask:0xf bank_mask:0xf
    v_add_f32_dpp v40, v41, v40 quad_perm:[1,1,1,1] row_mask:0xf bank_mask:0xf
    v_add_f32_dpp v44, v45, v44 quad_perm:[1,1,1,1] row_mask:0xf bank_mask:0xf
    v_add_f32_dpp v48, v49, v48 quad_perm:[1,1,1,1] row_mask:0xf bank_mask:0xf
    v_add_f32_dpp v52, v53, v52 quad_perm:[1,1,1,1] row_mask:0xf bank_mask:0xf
    v_add_f32_dpp v40, v42, v40 quad_perm:[2,2,2,2] row_mask:0xf bank_mask:0xf
    v_add_f32_dpp v44, v46, v44 quad_perm:[2,2,2,2] row_mask:0xf bank_mask:0xf
    v_add_f32_dpp v48, v50, v48 quad_perm:[2,2,2,2] row_mask:0xf bank_mask:0xf
    v_add_f32_dpp v52, v54, v52 quad_perm:[2,2,2,2] row_mask:0xf bank_mask:0xf
    v_add_f32_dpp v40, v43, v40 quad_perm:[3,3,3,3] row_mask:0xf bank_mask:0xf
    v_add_f32_dpp v44, v47, v44 quad_perm:[3,3,3,3] row_mask:0xf bank_mask:0xf
    v_add_f32_dpp v48, v51, v48 quad_perm:[3,3,3,3] row_mask:0xf bank_mask:0xf
    v_add_f32_dpp v52, v55, v52 quad_perm:[3,3,3,3] row_mask:0xf bank_mask:0xf
    v_max3_f32 v12, v40, v44, v48
    v_cndmask_b32 v14, v40, v44, s[78:79]
    v_max_f32 v12, v12, v52
    v_cndmask_b32 v14, v14, v48, s[80:81]
    v_cndmask_b32 v12, v10, v12, s[66:67]
    v_cndmask_b32 v14, v14, v52, s[82:83]
    v_max_f32 v8, v8, v12
    ds_write_b32 v15, v14 offset:256
    v_add_u32 v15, 512, v15
    s_sub_u32 s71, s71, 1
    s_cmp_lg_u32 s71, 0
    s_cbranch_scc1 L_k2
    s_mov_b32 s62, s9
    s_waitcnt vmcnt(0)
    s_and_b32 s6, s62, 2047
    s_lshr_b32 s7, s6, 9
    s_lshl_b32 s7, s7, 26
    s_and_b32 s6, s6, 511
    s_lshl_b32 s6, s6, 12
    s_or_b32 s6, s6, s7
    s_or_b32 s10, s6, s63
    s_add_u32 s62, s62, 28
    s_and_b32 s6, s62, 2047
    s_lshr_b32 s7, s6, 9
    s_lshl_b32 s7, s7, 26
    s_and_b32 s6, s6, 511
    s_lshl_b32 s6, s6, 12
    s_or_b32 s6, s6, s7
    s_or_b32 s11, s6, s63
    s_add_u32 s62, s62, 28
    buffer_load_dwordx4 v[88:91], v2, s[48:51], s10 offen offset:0 nt
    buffer_load_dwordx4 v[92:95], v2, s[48:51], s10 offen offset:1024 nt
    buffer_load_dwordx4 v[96:99], v2, s[48:51], s10 offen offset:2048 nt
    buffer_load_dwordx4 v[100:103], v2, s[48:51], s10 offen offset:3072 nt
    buffer_load_dwordx4 v[104:107], v2, s[48:51], s11 offen offset:0 nt
    buffer_load_dwordx4 v[108:111], v2, s[48:51], s11 offen offset:1024 nt
    buffer_load_dwordx4 v[112:115], v2, s[48:51], s11 offen offset:2048 nt
    buffer_load_dwordx4 v[116:119], v2, s[48:51], s11 offen offset:3072 nt
    v_mfma_f32_16x16x32_bf16 v[40:43], v[56:59], v[16:19], 0
    v_mfma_f32_16x16x32_bf16 v[44:47], v[60:63], v[16:19], 0
    v_mfma_f32_16x16x32_bf16 v[48:51], v[64:67], v[16:19], 0
    v_mfma_f32_16x16x32_bf16 v[52:55], v[68:71], v[16:19], 0
    s_bfe_u32 s6, s76, 0x20009
    s_lshl_b32 s6, s6, 2
    s_lshl_b64 s[66:67], s[68:69], s6
    s_add_u32 s76, s76, 28
    s_nop 0
    v_mov_b32_dpp v40, v40 quad_perm:[0,0,0,0] row_mask:0xf bank_mask:0xf
    v_mov_b32_dpp v44, v44 quad_perm:[0,0,0,0] row_mask:0xf bank_mask:0xf
    v_mov_b32_dpp v48, v48 quad_perm:[0,0,0,0] row_mask:0xf bank_mask:0xf
    v_mov_b32_dpp v52, v52 quad_perm:[0,0,0,0] row_mask:0xf bank_mask:0xf
    v_add_f32_dpp v40, v41, v40 quad_perm:[1,1,1,1] row_mask:0xf bank_mask:0xf
    v_add_f32_dpp v44, v45, v44 quad_perm:[1,1,1,1] row_mask:0xf bank_mask:0xf
    v_add_f32_dpp v48, v49, v48 quad_perm:[1,1,1,1] row_mask:0xf bank_mask:0xf
    v_add_f32_dpp v52, v53, v52 quad_perm:[1,1,1,1] row_mask:0xf bank_mask:0xf
    v_add_f32_dpp v40, v42, v40 quad_perm:[2,2,2,2] row_mask:0xf bank_mask:0xf
    v_add_f32_dpp v44, v46, v44 quad_perm:[2,2,2,2] row_mask:0xf bank_mask:0xf
    v_add_f32_dpp v48, v50, v48 quad_perm:[2,2,2,2] row_mask:0xf bank_mask:0xf
    v_add_f32_dpp v52, v54, v52 quad_perm:[2,2,2,2] row_mask:0xf bank_mask:0xf
    v_add_f32_dpp v40, v43, v40 quad_perm:[3,3,3,3] row_mask:0xf bank_mask:0xf
    v_add_f32_dpp v44, v47, v44 quad_perm:[3,3,3,3] row_mask:0xf bank_mask:0xf
    v_add_f32_dpp v48, v51, v48 quad_perm:[3,3,3,3] row_mask:0xf bank_mask:0xf
    v_add_f32_dpp v52, v55, v52 quad_perm:[3,3,3,3] row_mask:0xf bank_mask:0xf
    v_max3_f32 v12, v40, v44, v48
    v_cndmask_b32 v13, v40, v44, s[78:79]
    v_max_f32 v12, v12, v52
    v_cndmask_b32 v13, v13, v48, s[80:81]
    v_cndmask_b32 v12, v10, v12, s[66:67]
    v_cndmask_b32 v13, v13, v52, s[82:83]
    v_max_f32 v8, v8, v12
    ds_write_b32 v15, v13 offset:0
    v_mfma_f32_16x16x32_bf16 v[40:43], v[72:75], v[16:19], 0
    v_mfma_f32_16x16x32_bf16 v[44:47], v[76:79], v[16:19], 0
    v_mfma_f32_16x16x32_bf16 v[48:51], v[80:83], v[16:19], 0
    v_mfma_f32_16x16x32_bf16 v[52:55], v[84:87], v[16:19], 0
    s_bfe_u32 s6, s76, 0x20009
    s_lshl_b32 s6, s6, 2
    s_lshl_b64 s[66:67], s[68:69], s6
    s_add_u32 s76, s76, 28
    s_nop 0
    v_mov_b32_dpp v40, v40 quad_perm:[0,0,0,0] row_mask:0xf bank_mask:0xf
    v_mov_b32_dpp v44, v44 quad_perm:[0,0,0,0] row_mask:0xf bank_mask:0xf
    v_mov_b32_dpp v48, v48 quad_perm:[0,0,0,0] row_mask:0xf bank_mask:0xf
    v_mov_b32_dpp v52, v52 quad_perm:[0,0,0,0] row_mask:0xf bank_mask:0xf
    v_add_f32_dpp v40, v41, v40 quad_perm:[1,1,1,1] row_mask:0xf bank_mask:0xf
    v_add_f32_dpp v44, v45, v44 quad_perm:[1,1,1,1] row_mask:0xf bank_mask:0xf
    v_add_f32_dpp v48, v49, v48 quad_perm:[1,1,1,1] row_mask:0xf bank_mask:0xf
    v_add_f32_dpp v52, v53, v52 quad_perm:[1,1,1,1] row_mask:0xf bank_mask:0xf
    v_add_f32_dpp v40, v42, v40 quad_perm:[2,2,2,2] row_mask:0xf bank_mask:0xf
    v_add_f32_dpp v44, v46, v44 quad_perm:[2,2,2,2] row_mask:0xf bank_mask:0xf
    v_add_f32_dpp v48, v50, v48 quad_perm:[2,2,2,2] row_mask:0xf bank_mask:0xf
    v_add_f32_dpp v52, v54, v52 quad_perm:[2,2,2,2] row_mask:0xf bank_mask:0xf
    v_add_f32_dpp v40, v43, v40 quad_perm:[3,3,3,3] row_mask:0xf bank_mask:0xf
    v_add_f32_dpp v44, v47, v44 quad_perm:[3,3,3,3] row_mask:0xf bank_mask:0xf
    v_add_f32_dpp v48, v51, v48 quad_perm:[3,3,3,3] row_mask:0xf bank_mask:0xf
    v_add_f32_dpp v52, v55, v52 quad_perm:[3,3,3,3] row_mask:0xf bank_mask:0xf
    v_max3_f32 v12, v40, v44, v48
    v_cndmask_b32 v14, v40, v44, s[78:79]
    v_max_f32 v12, v12, v52
    v_cndmask_b32 v14, v14, v48, s[80:81]
    v_cndmask_b32 v12, v10, v12, s[66:67]
    v_cndmask_b32 v14, v14, v52, s[82:83]
    v_max_f32 v8, v8, v12
    ds_write_b32 v15, v14 offset:256
    v_add_u32 v15, 512, v15
    v_mul_f32 v8, s65, v8
    v_mov_b32 v13, v8
    s_nop 1
    v_permlane16_swap_b32 v8, v13
    s_nop 1
    v_max_f32 v8, v8, v13
    v_mov_b32 v13, v8
    s_nop 1
    v_permlane32_swap_b32 v8, v13
    s_nop 1
    v_max_f32 v8, v8, v13
    v_min_f32 v5, v5, -v8
    v_mov_b32 v8, 0
    s_add_u32 s6, s74, 6656
    v_lshl_add_u32 v15, v0, 2, s6
    s_mov_b32 s76, s9
    ds_read_b32 v13, v15
    ds_read_b32 v14, v15 offset:256
    v_add_u32 v15, 512, v15
    s_waitcnt vmcnt(0)
    s_and_b32 s6, s62, 2047
    s_lshr_b32 s7, s6, 9
    s_lshl_b32 s7, s7, 26
    s_and_b32 s6, s6, 511
    s_lshl_b32 s6, s6, 12
    s_or_b32 s6, s6, s7
    s_or_b32 s10, s6, s63
    s_add_u32 s62, s62, 28
    s_and_b32 s6, s62, 2047
    s_lshr_b32 s7, s6, 9
    s_lshl_b32 s7, s7, 26
    s_and_b32 s6, s6, 511
    s_lshl_b32 s6, s6, 12
    s_or_b32 s6, s6, s7
    s_or_b32 s11, s6, s63
    s_add_u32 s62, s62, 28
    buffer_load_dwordx4 v[56:59], v2, s[48:51], s10 offen offset:0 nt
    buffer_load_dwordx4 v[60:63], v2, s[48:51], s10 offen offset:1024 nt
    buffer_load_dwordx4 v[64:67], v2, s[48:51], s10 offen offset:2048 nt
    buffer_load_dwordx4 v[68:71], v2, s[48:51], s10 offen offset:3072 nt
    buffer_load_dwordx4 v[72:75], v2, s[48:51], s11 offen offset:0 nt
    buffer_load_dwordx4 v[76:79], v2, s[48:51], s11 offen offset:1024 nt
    buffer_load_dwordx4 v[80:83], v2, s[48:51], s11 offen offset:2048 nt
    buffer_load_dwordx4 v[84:87], v2, s[48:51], s11 offen offset:3072 nt
    s_waitcnt lgkmcnt(0)
    s_bfe_u32 s6, s76, 0x20009
    s_lshl_b32 s6, s6, 2
    s_lshl_b64 s[66:67], s[68:69], s6
    s_add_u32 s76, s76, 28
    v_cndmask_b32 v9, v10, v5, s[66:67]
    v_mov_b32_dpp v40, v13 quad_perm:[0,0,0,0] row_mask:0xf bank_mask:0xf
    v_mov_b32_dpp v44, v13 quad_perm:[1,1,1,1] row_mask:0xf bank_mask:0xf
    v_mov_b32_dpp v48, v13 quad_perm:[2,2,2,2] row_mask:0xf bank_mask:0xf
    v_mov_b32_dpp v52, v13 quad_perm:[3,3,3,3] row_mask:0xf bank_mask:0xf
    v_fma_f32 v41, v40, s65, v9
    v_fma_f32 v45, v44, s65, v9
    v_fma_f32 v49, v48, s65, v9
    v_fma_f32 v53, v52, s65, v9
    v_exp_f32 v41, v41
    v_exp_f32 v45, v45
    v_exp_f32 v49, v49
    v_exp_f32 v53, v53
    v_add_f32 v6, v6, v41
    v_add_f32 v6, v6, v45
    v_add_f32 v6, v6, v49
    v_add_f32 v6, v6, v53
    v_cvt_pk_bf16_f32 v41, v41, v41
    v_cvt_pk_bf16_f32 v45, v45, v45
    v_cvt_pk_bf16_f32 v49, v49, v49
    v_cvt_pk_bf16_f32 v53, v53, v53
    v_and_b32 v42, v41, v3
    v_and_b32 v43, v41, v4
    v_and_b32 v46, v45, v3
    v_and_b32 v47, v45, v4
    v_and_b32 v50, v49, v3
    v_and_b32 v51, v49, v4
    v_and_b32 v54, v53, v3
    v_and_b32 v55, v53, v4
    v_mfma_f32_16x16x16_bf16 v[24:27], v[42:43], v[88:89], v[24:27]
    v_mfma_f32_16x16x16_bf16 v[28:31], v[42:43], v[90:91], v[28:31]
    v_mfma_f32_16x16x16_bf16 v[24:27], v[46:47], v[92:93], v[24:27]
    v_mfma_f32_16x16x16_bf16 v[28:31], v[46:47], v[94:95], v[28:31]
    v_mfma_f32_16x16x16_bf16 v[24:27], v[50:51], v[96:97], v[24:27]
    v_mfma_f32_16x16x16_bf16 v[28:31], v[50:51], v[98:99], v[28:31]
    v_mfma_f32_16x16x16_bf16 v[24:27], v[54:55], v[100:101], v[24:27]
    v_mfma_f32_16x16x16_bf16 v[28:31], v[54:55], v[102:103], v[28:31]
    s_bfe_u32 s6, s76, 0x20009
    s_lshl_b32 s6, s6, 2
    s_lshl_b64 s[66:67], s[68:69], s6
    s_add_u32 s76, s76, 28
    v_cndmask_b32 v9, v10, v5, s[66:67]
    v_mov_b32_dpp v40, v14 quad_perm:[0,0,0,0] row_mask:0xf bank_mask:0xf
    v_mov_b32_dpp v44, v14 quad_perm:[1,1,1,1] row_mask:0xf bank_mask:0xf
    v_mov_b32_dpp v48, v14 quad_perm:[2,2,2,2] row_mask:0xf bank_mask:0xf
    v_mov_b32_dpp v52, v14 quad_perm:[3,3,3,3] row_mask:0xf bank_mask:0xf
    v_fma_f32 v41, v40, s65, v9
    v_fma_f32 v45, v44, s65, v9
    v_fma_f32 v49, v48, s65, v9
    v_fma_f32 v53, v52, s65, v9
    v_exp_f32 v41, v41
    v_exp_f32 v45, v45
    v_exp_f32 v49, v49
    v_exp_f32 v53, v53
    v_add_f32 v6, v6, v41
    v_add_f32 v6, v6, v45
    v_add_f32 v6, v6, v49
    v_add_f32 v6, v6, v53
    v_cvt_pk_bf16_f32 v41, v41, v41
    v_cvt_pk_bf16_f32 v45, v45, v45
    v_cvt_pk_bf16_f32 v49, v49, v49
    v_cvt_pk_bf16_f32 v53, v53, v53
    v_and_b32 v42, v41, v3
    v_and_b32 v43, v41, v4
    v_and_b32 v46, v45, v3
    v_and_b32 v47, v45, v4
    v_and_b32 v50, v49, v3
    v_and_b32 v51, v49, v4
    v_and_b32 v54, v53, v3
    v_and_b32 v55, v53, v4
    v_mfma_f32_16x16x16_bf16 v[24:27], v[42:43], v[104:105], v[24:27]
    v_mfma_f32_16x16x16_bf16 v[28:31], v[42:43], v[106:107], v[28:31]
    v_mfma_f32_16x16x16_bf16 v[24:27], v[46:47], v[108:109], v[24:27]
    v_mfma_f32_16x16x16_bf16 v[28:31], v[46:47], v[110:111], v[28:31]
    v_mfma_f32_16x16x16_bf16 v[24:27], v[50:51], v[112:113], v[24:27]
    v_mfma_f32_16x16x16_bf16 v[28:31], v[50:51], v[114:115], v[28:31]
    v_mfma_f32_16x16x16_bf16 v[24:27], v[54:55], v[116:117], v[24:27]
    v_mfma_f32_16x16x16_bf16 v[28:31], v[54:55], v[118:119], v[28:31]
    s_mov_b32 s71, 7
L_v2:
    ds_read_b32 v13, v15
    ds_read_b32 v14, v15 offset:256
    v_add_u32 v15, 512, v15
    s_waitcnt vmcnt(0)
    s_and_b32 s6, s62, 2047
    s_lshr_b32 s7, s6, 9
    s_lshl_b32 s7, s7, 26
    s_and_b32 s6, s6, 511
    s_lshl_b32 s6, s6, 12
    s_or_b32 s6, s6, s7
    s_or_b32 s10, s6, s63
    s_add_u32 s62, s62, 28
    s_and_b32 s6, s62, 2047
    s_lshr_b32 s7, s6, 9
    s_lshl_b32 s7, s7, 26
    s_and_b32 s6, s6, 511
    s_lshl_b32 s6, s6, 12
    s_or_b32 s6, s6, s7
    s_or_b32 s11, s6, s63
    s_add_u32 s62, s62, 28
    buffer_load_dwordx4 v[88:91], v2, s[48:51], s10 offen offset:0 nt
    buffer_load_dwordx4 v[92:95], v2, s[48:51], s10 offen offset:1024 nt
    buffer_load_dwordx4 v[96:99], v2, s[48:51], s10 offen offset:2048 nt
    buffer_load_dwordx4 v[100:103], v2, s[48:51], s10 offen offset:3072 nt
    buffer_load_dwordx4 v[104:107], v2, s[48:51], s11 offen offset:0 nt
    buffer_load_dwordx4 v[108:111], v2, s[48:51], s11 offen offset:1024 nt
    buffer_load_dwordx4 v[112:115], v2, s[48:51], s11 offen offset:2048 nt
    buffer_load_dwordx4 v[116:119], v2, s[48:51], s11 offen offset:3072 nt
    s_waitcnt lgkmcnt(0)
    s_bfe_u32 s6, s76, 0x20009
    s_lshl_b32 s6, s6, 2
    s_lshl_b64 s[66:67], s[68:69], s6
    s_add_u32 s76, s76, 28
    v_cndmask_b32 v9, v10, v5, s[66:67]
    v_mov_b32_dpp v40, v13 quad_perm:[0,0,0,0] row_mask:0xf bank_mask:0xf
    v_mov_b32_dpp v44, v13 quad_perm:[1,1,1,1] row_mask:0xf bank_mask:0xf
    v_mov_b32_dpp v48, v13 quad_perm:[2,2,2,2] row_mask:0xf bank_mask:0xf
    v_mov_b32_dpp v52, v13 quad_perm:[3,3,3,3] row_mask:0xf bank_mask:0xf
    v_fma_f32 v41, v40, s65, v9
    v_fma_f32 v45, v44, s65, v9
    v_fma_f32 v49, v48, s65, v9
    v_fma_f32 v53, v52, s65, v9
    v_exp_f32 v41, v41
    v_exp_f32 v45, v45
    v_exp_f32 v49, v49
    v_exp_f32 v53, v53
    v_add_f32 v6, v6, v41
    v_add_f32 v6, v6, v45
    v_add_f32 v6, v6, v49
    v_add_f32 v6, v6, v53
    v_cvt_pk_bf16_f32 v41, v41, v41
    v_cvt_pk_bf16_f32 v45, v45, v45
    v_cvt_pk_bf16_f32 v49, v49, v49
    v_cvt_pk_bf16_f32 v53, v53, v53
    v_and_b32 v42, v41, v3
    v_and_b32 v43, v41, v4
    v_and_b32 v46, v45, v3
    v_and_b32 v47, v45, v4
    v_and_b32 v50, v49, v3
    v_and_b32 v51, v49, v4
    v_and_b32 v54, v53, v3
    v_and_b32 v55, v53, v4
    v_mfma_f32_16x16x16_bf16 v[24:27], v[42:43], v[56:57], v[24:27]
    v_mfma_f32_16x16x16_bf16 v[28:31], v[42:43], v[58:59], v[28:31]
    v_mfma_f32_16x16x16_bf16 v[24:27], v[46:47], v[60:61], v[24:27]
    v_mfma_f32_16x16x16_bf16 v[28:31], v[46:47], v[62:63], v[28:31]
    v_mfma_f32_16x16x16_bf16 v[24:27], v[50:51], v[64:65], v[24:27]
    v_mfma_f32_16x16x16_bf16 v[28:31], v[50:51], v[66:67], v[28:31]
    v_mfma_f32_16x16x16_bf16 v[24:27], v[54:55], v[68:69], v[24:27]
    v_mfma_f32_16x16x16_bf16 v[28:31], v[54:55], v[70:71], v[28:31]
    s_bfe_u32 s6, s76, 0x20009
    s_lshl_b32 s6, s6, 2
    s_lshl_b64 s[66:67], s[68:69], s6
    s_add_u32 s76, s76, 28
    v_cndmask_b32 v9, v10, v5, s[66:67]
    v_mov_b32_dpp v40, v14 quad_perm:[0,0,0,0] row_mask:0xf bank_mask:0xf
    v_mov_b32_dpp v44, v14 quad_perm:[1,1,1,1] row_mask:0xf bank_mask:0xf
    v_mov_b32_dpp v48, v14 quad_perm:[2,2,2,2] row_mask:0xf bank_mask:0xf
    v_mov_b32_dpp v52, v14 quad_perm:[3,3,3,3] row_mask:0xf bank_mask:0xf
    v_fma_f32 v41, v40, s65, v9
    v_fma_f32 v45, v44, s65, v9
    v_fma_f32 v49, v48, s65, v9
    v_fma_f32 v53, v52, s65, v9
    v_exp_f32 v41, v41
    v_exp_f32 v45, v45
    v_exp_f32 v49, v49
    v_exp_f32 v53, v53
    v_add_f32 v6, v6, v41
    v_add_f32 v6, v6, v45
    v_add_f32 v6, v6, v49
    v_add_f32 v6, v6, v53
    v_cvt_pk_bf16_f32 v41, v41, v41
    v_cvt_pk_bf16_f32 v45, v45, v45
    v_cvt_pk_bf16_f32 v49, v49, v49
    v_cvt_pk_bf16_f32 v53, v53, v53
    v_and_b32 v42, v41, v3
    v_and_b32 v43, v41, v4
    v_and_b32 v46, v45, v3
    v_and_b32 v47, v45, v4
    v_and_b32 v50, v49, v3
    v_and_b32 v51, v49, v4
    v_and_b32 v54, v53, v3
    v_and_b32 v55, v53, v4
    v_mfma_f32_16x16x16_bf16 v[24:27], v[42:43], v[72:73], v[24:27]
    v_mfma_f32_16x16x16_bf16 v[28:31], v[42:43], v[74:75], v[28:31]
    v_mfma_f32_16x16x16_bf16 v[24:27], v[46:47], v[76:77], v[24:27]
    v_mfma_f32_16x16x16_bf16 v[28:31], v[46:47], v[78:79], v[28:31]
    v_mfma_f32_16x16x16_bf16 v[24:27], v[50:51], v[80:81], v[24:27]
    v_mfma_f32_16x16x16_bf16 v[28:31], v[50:51], v[82:83], v[28:31]
    v_mfma_f32_16x16x16_bf16 v[24:27], v[54:55], v[84:85], v[24:27]
    v_mfma_f32_16x16x16_bf16 v[28:31], v[54:55], v[86:87], v[28:31]
    ds_read_b32 v13, v15
    ds_read_b32 v14, v15 offset:256
    v_add_u32 v15, 512, v15
    s_waitcnt vmcnt(0)
    s_and_b32 s6, s62, 2047
    s_lshr_b32 s7, s6, 9
    s_lshl_b32 s7, s7, 26
    s_and_b32 s6, s6, 511
    s_lshl_b32 s6, s6, 12
    s_or_b32 s6, s6, s7
    s_or_b32 s10, s6, s63
    s_add_u32 s62, s62, 28
    s_and_b32 s6, s62, 2047
    s_lshr_b32 s7, s6, 9
    s_lshl_b32 s7, s7, 26
    s_and_b32 s6, s6, 511
    s_lshl_b32 s6, s6, 12
    s_or_b32 s6, s6, s7
    s_or_b32 s11, s6, s63
    s_add_u32 s62, s62, 28
    buffer_load_dwordx4 v[56:59], v2, s[48:51], s10 offen offset:0 nt
    buffer_load_dwordx4 v[60:63], v2, s[48:51], s10 offen offset:1024 nt
    buffer_load_dwordx4 v[64:67], v2, s[48:51], s10 offen offset:2048 nt
    buffer_load_dwordx4 v[68:71], v2, s[48:51], s10 offen offset:3072 nt
    buffer_load_dwordx4 v[72:75], v2, s[48:51], s11 offen offset:0 nt
    buffer_load_dwordx4 v[76:79], v2, s[48:51], s11 offen offset:1024 nt
    buffer_load_dwordx4 v[80:83], v2, s[48:51], s11 offen offset:2048 nt
    buffer_load_dwordx4 v[84:87], v2, s[48:51], s11 offen offset:3072 nt
    s_waitcnt lgkmcnt(0)
    s_bfe_u32 s6, s76, 0x20009
    s_lshl_b32 s6, s6, 2
    s_lshl_b64 s[66:67], s[68:69], s6
    s_add_u32 s76, s76, 28
    v_cndmask_b32 v9, v10, v5, s[66:67]
    v_mov_b32_dpp v40, v13 quad_perm:[0,0,0,0] row_mask:0xf bank_mask:0xf
    v_mov_b32_dpp v44, v13 quad_perm:[1,1,1,1] row_mask:0xf bank_mask:0xf
    v_mov_b32_dpp v48, v13 quad_perm:[2,2,2,2] row_mask:0xf bank_mask:0xf
    v_mov_b32_dpp v52, v13 quad_perm:[3,3,3,3] row_mask:0xf bank_mask:0xf
    v_fma_f32 v41, v40, s65, v9
    v_fma_f32 v45, v44, s65, v9
    v_fma_f32 v49, v48, s65, v9
    v_fma_f32 v53, v52, s65, v9
    v_exp_f32 v41, v41
    v_exp_f32 v45, v45
    v_exp_f32 v49, v49
    v_exp_f32 v53, v53
    v_add_f32 v6, v6, v41
    v_add_f32 v6, v6, v45
    v_add_f32 v6, v6, v49
    v_add_f32 v6, v6, v53
    v_cvt_pk_bf16_f32 v41, v41, v41
    v_cvt_pk_bf16_f32 v45, v45, v45
    v_cvt_pk_bf16_f32 v49, v49, v49
    v_cvt_pk_bf16_f32 v53, v53, v53
    v_and_b32 v42, v41, v3
    v_and_b32 v43, v41, v4
    v_and_b32 v46, v45, v3
    v_and_b32 v47, v45, v4
    v_and_b32 v50, v49, v3
    v_and_b32 v51, v49, v4
    v_and_b32 v54, v53, v3
    v_and_b32 v55, v53, v4
    v_mfma_f32_16x16x16_bf16 v[24:27], v[42:43], v[88:89], v[24:27]
    v_mfma_f32_16x16x16_bf16 v[28:31], v[42:43], v[90:91], v[28:31]
    v_mfma_f32_16x16x16_bf16 v[24:27], v[46:47], v[92:93], v[24:27]
    v_mfma_f32_16x16x16_bf16 v[28:31], v[46:47], v[94:95], v[28:31]
    v_mfma_f32_16x16x16_bf16 v[24:27], v[50:51], v[96:97], v[24:27]
    v_mfma_f32_16x16x16_bf16 v[28:31], v[50:51], v[98:99], v[28:31]
    v_mfma_f32_16x16x16_bf16 v[24:27], v[54:55], v[100:101], v[24:27]
    v_mfma_f32_16x16x16_bf16 v[28:31], v[54:55], v[102:103], v[28:31]
    s_bfe_u32 s6, s76, 0x20009
    s_lshl_b32 s6, s6, 2
    s_lshl_b64 s[66:67], s[68:69], s6
    s_add_u32 s76, s76, 28
    v_cndmask_b32 v9, v10, v5, s[66:67]
    v_mov_b32_dpp v40, v14 quad_perm:[0,0,0,0] row_mask:0xf bank_mask:0xf
    v_mov_b32_dpp v44, v14 quad_perm:[1,1,1,1] row_mask:0xf bank_mask:0xf
    v_mov_b32_dpp v48, v14 quad_perm:[2,2,2,2] row_mask:0xf bank_mask:0xf
    v_mov_b32_dpp v52, v14 quad_perm:[3,3,3,3] row_mask:0xf bank_mask:0xf
    v_fma_f32 v41, v40, s65, v9
    v_fma_f32 v45, v44, s65, v9
    v_fma_f32 v49, v48, s65, v9
    v_fma_f32 v53, v52, s65, v9
    v_exp_f32 v41, v41
    v_exp_f32 v45, v45
    v_exp_f32 v49, v49
    v_exp_f32 v53, v53
    v_add_f32 v6, v6, v41
    v_add_f32 v6, v6, v45
    v_add_f32 v6, v6, v49
    v_add_f32 v6, v6, v53
    v_cvt_pk_bf16_f32 v41, v41, v41
    v_cvt_pk_bf16_f32 v45, v45, v45
    v_cvt_pk_bf16_f32 v49, v49, v49
    v_cvt_pk_bf16_f32 v53, v53, v53
    v_and_b32 v42, v41, v3
    v_and_b32 v43, v41, v4
    v_and_b32 v46, v45, v3
    v_and_b32 v47, v45, v4
    v_and_b32 v50, v49, v3
    v_and_b32 v51, v49, v4
    v_and_b32 v54, v53, v3
    v_and_b32 v55, v53, v4
    v_mfma_f32_16x16x16_bf16 v[24:27], v[42:43], v[104:105], v[24:27]
    v_mfma_f32_16x16x16_bf16 v[28:31], v[42:43], v[106:107], v[28:31]
    v_mfma_f32_16x16x16_bf16 v[24:27], v[46:47], v[108:109], v[24:27]
    v_mfma_f32_16x16x16_bf16 v[28:31], v[46:47], v[110:111], v[28:31]
    v_mfma_f32_16x16x16_bf16 v[24:27], v[50:51], v[112:113], v[24:27]
    v_mfma_f32_16x16x16_bf16 v[28:31], v[50:51], v[114:115], v[28:31]
    v_mfma_f32_16x16x16_bf16 v[24:27], v[54:55], v[116:117], v[24:27]
    v_mfma_f32_16x16x16_bf16 v[28:31], v[54:55], v[118:119], v[28:31]
    s_sub_u32 s71, s71, 1
    s_cmp_lg_u32 s71, 0
    s_cbranch_scc1 L_v2
    s_mov_b32 s62, s8
    ds_read_b32 v13, v15
    ds_read_b32 v14, v15 offset:256
    v_add_u32 v15, 512, v15
    s_waitcnt vmcnt(0)
    s_and_b32 s6, s62, 2047
    s_lshr_b32 s7, s6, 9
    s_lshl_b32 s7, s7, 26
    s_and_b32 s6, s6, 511
    s_lshl_b32 s6, s6, 12
    s_or_b32 s6, s6, s7
    s_or_b32 s10, s6, s63
    s_add_u32 s62, s62, 32
    s_and_b32 s6, s62, 2047
    s_lshr_b32 s7, s6, 9
    s_lshl_b32 s7, s7, 26
    s_and_b32 s6, s6, 511
    s_lshl_b32 s6, s6, 12
    s_or_b32 s6, s6, s7
    s_or_b32 s11, s6, s63
    s_add_u32 s62, s62, 32
    buffer_load_dwordx4 v[88:91], v2, s[48:51], s10 offen offset:0 nt
    buffer_load_dwordx4 v[92:95], v2, s[48:51], s10 offen offset:1024 nt
    buffer_load_dwordx4 v[96:99], v2, s[48:51], s10 offen offset:2048 nt
    buffer_load_dwordx4 v[100:103], v2, s[48:51], s10 offen offset:3072 nt
    buffer_load_dwordx4 v[104:107], v2, s[48:51], s11 offen offset:0 nt
    buffer_load_dwordx4 v[108:111], v2, s[48:51], s11 offen offset:1024 nt
    buffer_load_dwordx4 v[112:115], v2, s[48:51], s11 offen offset:2048 nt
    buffer_load_dwordx4 v[116:119], v2, s[48:51], s11 offen offset:3072 nt
    s_waitcnt lgkmcnt(0)
    s_bfe_u32 s6, s76, 0x20009
    s_lshl_b32 s6, s6, 2
    s_lshl_b64 s[66:67], s[68:69], s6
    s_add_u32 s76, s76, 28
    v_cndmask_b32 v9, v10, v5, s[66:67]
    v_mov_b32_dpp v40, v13 quad_perm:[0,0,0,0] row_mask:0xf bank_mask:0xf
    v_mov_b32_dpp v44, v13 quad_perm:[1,1,1,1] row_mask:0xf bank_mask:0xf
    v_mov_b32_dpp v48, v13 quad_perm:[2,2,2,2] row_mask:0xf bank_mask:0xf
    v_mov_b32_dpp v52, v13 quad_perm:[3,3,3,3] row_mask:0xf bank_mask:0xf
    v_fma_f32 v41, v40, s65, v9
    v_fma_f32 v45, v44, s65, v9
    v_fma_f32 v49, v48, s65, v9
    v_fma_f32 v53, v52, s65, v9
    v_exp_f32 v41, v41
    v_exp_f32 v45, v45
    v_exp_f32 v49, v49
    v_exp_f32 v53, v53
    v_add_f32 v6, v6, v41
    v_add_f32 v6, v6, v45
    v_add_f32 v6, v6, v49
    v_add_f32 v6, v6, v53
    v_cvt_pk_bf16_f32 v41, v41, v41
    v_cvt_pk_bf16_f32 v45, v45, v45
    v_cvt_pk_bf16_f32 v49, v49, v49
    v_cvt_pk_bf16_f32 v53, v53, v53
    v_and_b32 v42, v41, v3
    v_and_b32 v43, v41, v4
    v_and_b32 v46, v45, v3
    v_and_b32 v47, v45, v4
    v_and_b32 v50, v49, v3
    v_and_b32 v51, v49, v4
    v_and_b32 v54, v53, v3
    v_and_b32 v55, v53, v4
    v_mfma_f32_16x16x16_bf16 v[24:27], v[42:43], v[56:57], v[24:27]
    v_mfma_f32_16x16x16_bf16 v[28:31], v[42:43], v[58:59], v[28:31]
    v_mfma_f32_16x16x16_bf16 v[24:27], v[46:47], v[60:61], v[24:27]
    v_mfma_f32_16x16x16_bf16 v[28:31], v[46:47], v[62:63], v[28:31]
    v_mfma_f32_16x16x16_bf16 v[24:27], v[50:51], v[64:65], v[24:27]
    v_mfma_f32_16x16x16_bf16 v[28:31], v[50:51], v[66:67], v[28:31]
    v_mfma_f32_16x16x16_bf16 v[24:27], v[54:55], v[68:69], v[24:27]
    v_mfma_f32_16x16x16_bf16 v[28:31], v[54:55], v[70:71], v[28:31]
    s_bfe_u32 s6, s76, 0x20009
    s_lshl_b32 s6, s6, 2
    s_lshl_b64 s[66:67], s[68:69], s6
    s_add_u32 s76, s76, 28
    v_cndmask_b32 v9, v10, v5, s[66:67]
    v_mov_b32_dpp v40, v14 quad_perm:[0,0,0,0] row_mask:0xf bank_mask:0xf
    v_mov_b32_dpp v44, v14 quad_perm:[1,1,1,1] row_mask:0xf bank_mask:0xf
    v_mov_b32_dpp v48, v14 quad_perm:[2,2,2,2] row_mask:0xf bank_mask:0xf
    v_mov_b32_dpp v52, v14 quad_perm:[3,3,3,3] row_mask:0xf bank_mask:0xf
    v_fma_f32 v41, v40, s65, v9
    v_fma_f32 v45, v44, s65, v9
    v_fma_f32 v49, v48, s65, v9
    v_fma_f32 v53, v52, s65, v9
    v_exp_f32 v41, v41
    v_exp_f32 v45, v45
    v_exp_f32 v49, v49
    v_exp_f32 v53, v53
    v_add_f32 v6, v6, v41
    v_add_f32 v6, v6, v45
    v_add_f32 v6, v6, v49
    v_add_f32 v6, v6, v53
    v_cvt_pk_bf16_f32 v41, v41, v41
    v_cvt_pk_bf16_f32 v45, v45, v45
    v_cvt_pk_bf16_f32 v49, v49, v49
    v_cvt_pk_bf16_f32 v53, v53, v53
    v_and_b32 v42, v41, v3
    v_and_b32 v43, v41, v4
    v_and_b32 v46, v45, v3
    v_and_b32 v47, v45, v4
    v_and_b32 v50, v49, v3
    v_and_b32 v51, v49, v4
    v_and_b32 v54, v53, v3
    v_and_b32 v55, v53, v4
    v_mfma_f32_16x16x16_bf16 v[24:27], v[42:43], v[72:73], v[24:27]
    v_mfma_f32_16x16x16_bf16 v[28:31], v[42:43], v[74:75], v[28:31]
    v_mfma_f32_16x16x16_bf16 v[24:27], v[46:47], v[76:77], v[24:27]
    v_mfma_f32_16x16x16_bf16 v[28:31], v[46:47], v[78:79], v[28:31]
    v_mfma_f32_16x16x16_bf16 v[24:27], v[50:51], v[80:81], v[24:27]
    v_mfma_f32_16x16x16_bf16 v[28:31], v[50:51], v[82:83], v[28:31]
    v_mfma_f32_16x16x16_bf16 v[24:27], v[54:55], v[84:85], v[24:27]
    v_mfma_f32_16x16x16_bf16 v[28:31], v[54:55], v[86:87], v[28:31]
    s_branch L_v1_start
L_phaseA:
    s_waitcnt vmcnt(0)
    s_and_b32 s6, s73, 127
    s_lshl_b32 s6, s6, 12
    s_add_u32 s12, s6, s64
    s_add_u32 s73, s73, 4
    buffer_load_dwordx4 v[120:123], v1, s[52:55], s12 offen offset:0 nt
    buffer_load_dwordx4 v[124:127], v1, s[52:55], s12 offen offset:1024 nt
    buffer_load_dwordx4 v[128:131], v1, s[52:55], s12 offen offset:2048 nt
    buffer_load_dwordx4 v[132:135], v1, s[52:55], s12 offen offset:3072 nt
    buffer_load_dwordx4 v[136:139], v2, s[56:59], s12 offen offset:0 nt
    buffer_load_dwordx4 v[140:143], v2, s[56:59], s12 offen offset:1024 nt
    buffer_load_dwordx4 v[144:147], v2, s[56:59], s12 offen offset:2048 nt
    buffer_load_dwordx4 v[148:151], v2, s[56:59], s12 offen offset:3072 nt
    v_mfma_f32_16x16x32_bf16 v[40:43], v[56:59], v[16:19], 0
    v_mfma_f32_16x16x32_bf16 v[44:47], v[60:63], v[16:19], 0
    v_mfma_f32_16x16x32_bf16 v[48:51], v[64:67], v[16:19], 0
    v_mfma_f32_16x16x32_bf16 v[52:55], v[68:71], v[16:19], 0
    s_bfe_u32 s6, s76, 0x20009
    s_lshl_b32 s6, s6, 2
    s_lshl_b64 s[66:67], s[68:69], s6
    s_add_u32 s76, s76, 32
    s_nop 0
    v_mov_b32_dpp v40, v40 quad_perm:[0,0,0,0] row_mask:0xf bank_mask:0xf
    v_mov_b32_dpp v44, v44 quad_perm:[0,0,0,0] row_mask:0xf bank_mask:0xf
    v_mov_b32_dpp v48, v48 quad_perm:[0,0,0,0] row_mask:0xf bank_mask:0xf
    v_mov_b32_dpp v52, v52 quad_perm:[0,0,0,0] row_mask:0xf bank_mask:0xf
    v_add_f32_dpp v40, v41, v40 quad_perm:[1,1,1,1] row_mask:0xf bank_mask:0xf
    v_add_f32_dpp v44, v45, v44 quad_perm:[1,1,1,1] row_mask:0xf bank_mask:0xf
    v_add_f32_dpp v48, v49, v48 quad_perm:[1,1,1,1] row_mask:0xf bank_mask:0xf
    v_add_f32_dpp v52, v53, v52 quad_perm:[1,1,1,1] row_mask:0xf bank_mask:0xf
    v_add_f32_dpp v40, v42, v40 quad_perm:[2,2,2,2] row_mask:0xf bank_mask:0xf
    v_add_f32_dpp v44, v46, v44 quad_perm:[2,2,2,2] row_mask:0xf bank_mask:0xf
    v_add_f32_dpp v48, v50, v48 quad_perm:[2,2,2,2] row_mask:0xf bank_mask:0xf
    v_add_f32_dpp v52, v54, v52 quad_perm:[2,2,2,2] row_mask:0xf bank_mask:0xf
    v_add_f32_dpp v40, v43, v40 quad_perm:[3,3,3,3] row_mask:0xf bank_mask:0xf
    v_add_f32_dpp v44, v47, v44 quad_perm:[3,3,3,3] row_mask:0xf bank_mask:0xf
    v_add_f32_dpp v48, v51, v48 quad_perm:[3,3,3,3] row_mask:0xf bank_mask:0xf
    v_add_f32_dpp v52, v55, v52 quad_perm:[3,3,3,3] row_mask:0xf bank_mask:0xf
    v_max3_f32 v12, v40, v44, v48
    v_cndmask_b32 v13, v40, v44, s[78:79]
    v_max_f32 v12, v12, v52
    v_cndmask_b32 v13, v13, v48, s[80:81]
    v_cndmask_b32 v12, v10, v12, s[66:67]
    v_cndmask_b32 v13, v13, v52, s[82:83]
    v_max_f32 v8, v8, v12
    ds_write_b32 v15, v13 offset:0
    v_mfma_f32_16x16x32_bf16 v[40:43], v[72:75], v[16:19], 0
    v_mfma_f32_16x16x32_bf16 v[44:47], v[76:79], v[16:19], 0
    v_mfma_f32_16x16x32_bf16 v[48:51], v[80:83], v[16:19], 0
    v_mfma_f32_16x16x32_bf16 v[52:55], v[84:87], v[16:19], 0
    s_bfe_u32 s6, s76, 0x20009
    s_lshl_b32 s6, s6, 2
    s_lshl_b64 s[66:67], s[68:69], s6
    s_add_u32 s76, s76, 32
    s_nop 0
    v_mov_b32_dpp v40, v40 quad_perm:[0,0,0,0] row_mask:0xf bank_mask:0xf
    v_mov_b32_dpp v44, v44 quad_perm:[0,0,0,0] row_mask:0xf bank_mask:0xf
    v_mov_b32_dpp v48, v48 quad_perm:[0,0,0,0] row_mask:0xf bank_mask:0xf
    v_mov_b32_dpp v52, v52 quad_perm:[0,0,0,0] row_mask:0xf bank_mask:0xf
    v_add_f32_dpp v40, v41, v40 quad_perm:[1,1,1,1] row_mask:0xf bank_mask:0xf
    v_add_f32_dpp v44, v45, v44 quad_perm:[1,1,1,1] row_mask:0xf bank_mask:0xf
    v_add_f32_dpp v48, v49, v48 quad_perm:[1,1,1,1] row_mask:0xf bank_mask:0xf
    v_add_f32_dpp v52, v53, v52 quad_perm:[1,1,1,1] row_mask:0xf bank_mask:0xf
    v_add_f32_dpp v40, v42, v40 quad_perm:[2,2,2,2] row_mask:0xf bank_mask:0xf
    v_add_f32_dpp v44, v46, v44 quad_perm:[2,2,2,2] row_mask:0xf bank_mask:0xf
    v_add_f32_dpp v48, v50, v48 quad_perm:[2,2,2,2] row_mask:0xf bank_mask:0xf
    v_add_f32_dpp v52, v54, v52 quad_perm:[2,2,2,2] row_mask:0xf bank_mask:0xf
    v_add_f32_dpp v40, v43, v40 quad_perm:[3,3,3,3] row_mask:0xf bank_mask:0xf
    v_add_f32_dpp v44, v47, v44 quad_perm:[3,3,3,3] row_mask:0xf bank_mask:0xf
    v_add_f32_dpp v48, v51, v48 quad_perm:[3,3,3,3] row_mask:0xf bank_mask:0xf
    v_add_f32_dpp v52, v55, v52 quad_perm:[3,3,3,3] row_mask:0xf bank_mask:0xf
    v_max3_f32 v12, v40, v44, v48
    v_cndmask_b32 v14, v40, v44, s[78:79]
    v_max_f32 v12, v12, v52
    v_cndmask_b32 v14, v14, v48, s[80:81]
    v_cndmask_b32 v12, v10, v12, s[66:67]
    v_cndmask_b32 v14, v14, v52, s[82:83]
    v_max_f32 v8, v8, v12
    ds_write_b32 v15, v14 offset:256
    v_add_u32 v15, 512, v15
    v_mul_f32 v8, s65, v8
    v_mov_b32 v13, v8
    s_nop 1
    v_permlane16_swap_b32 v8, v13
    s_nop 1
    v_max_f32 v8, v8, v13
    v_mov_b32 v13, v8
    s_nop 1
    v_permlane32_swap_b32 v8, v13
    s_nop 1
    v_max_f32 v8, v8, v13
    v_min_f32 v5, v5, -v8
    v_mov_b32 v8, 0
    s_mov_b32 s7, 524288
    v_mov_b32 v12, 2048
L_wait_3:
    ds_read_b32 v13, v12 offset:0
    s_waitcnt lgkmcnt(0)
    v_readfirstlane_b32 s6, v13
    s_cmp_lg_u32 s6, 0
    s_cbranch_scc1 L_set_4
    s_sleep 2
    s_sub_u32 s7, s7, 1
    s_cmp_lg_u32 s7, 0
    s_cbranch_scc1 L_wait_3
L_set_4:
    ds_read_b128 v[20:23], v1 offset:1024
    s_waitcnt lgkmcnt(0)
    s_and_b32 s6, s73, 127
    s_lshl_b32 s6, s6, 12
    s_add_u32 s13, s6, s64
    s_add_u32 s73, s73, 4
    s_waitcnt vmcnt(0)
    v_mfma_f32_16x16x32_bf16 v[40:43], v[120:123], v[20:23], 0
    v_mfma_f32_16x16x32_bf16 v[44:47], v[124:127], v[20:23], 0
    v_mfma_f32_16x16x32_bf16 v[48:51], v[128:131], v[20:23], 0
    v_mfma_f32_16x16x32_bf16 v[52:55], v[132:135], v[20:23], 0
    buffer_load_dwordx4 v[120:123], v1, s[52:55], s13 offen offset:0 nt
    buffer_load_dwordx4 v[124:127], v1, s[52:55], s13 offen offset:1024 nt
    buffer_load_dwordx4 v[128:131], v1, s[52:55], s13 offen offset:2048 nt
    buffer_load_dwordx4 v[132:135], v1, s[52:55], s13 offen offset:3072 nt
    buffer_load_dwordx4 v[168:171], v2, s[56:59], s13 offen offset:0 nt
    buffer_load_dwordx4 v[172:175], v2, s[56:59], s13 offen offset:1024 nt
    buffer_load_dwordx4 v[176:179], v2, s[56:59], s13 offen offset:2048 nt
    buffer_load_dwordx4 v[180:183], v2, s[56:59], s13 offen offset:3072 nt
    v_mov_b32_dpp v40, v40 quad_perm:[0,0,0,0] row_mask:0xf bank_mask:0xf
    v_mov_b32_dpp v44, v44 quad_perm:[0,0,0,0] row_mask:0xf bank_mask:0xf
    v_mov_b32_dpp v48, v48 quad_perm:[0,0,0,0] row_mask:0xf bank_mask:0xf
    v_mov_b32_dpp v52, v52 quad_perm:[0,0,0,0] row_mask:0xf bank_mask:0xf
    v_add_f32_dpp v40, v41, v40 quad_perm:[1,1,1,1] row_mask:0xf bank_mask:0xf
    v_add_f32_dpp v44, v45, v44 quad_perm:[1,1,1,1] row_mask:0xf bank_mask:0xf
    v_add_f32_dpp v48, v49, v48 quad_perm:[1,1,1,1] row_mask:0xf bank_mask:0xf
    v_add_f32_dpp v52, v53, v52 quad_perm:[1,1,1,1] row_mask:0xf bank_mask:0xf
    v_add_f32_dpp v40, v42, v40 quad_perm:[2,2,2,2] row_mask:0xf bank_mask:0xf
    v_add_f32_dpp v44, v46, v44 quad_perm:[2,2,2,2] row_mask:0xf bank_mask:0xf
    v_add_f32_dpp v48, v50, v48 quad_perm:[2,2,2,2] row_mask:0xf bank_mask:0xf
    v_add_f32_dpp v52, v54, v52 quad_perm:[2,2,2,2] row_mask:0xf bank_mask:0xf
    v_add_f32_dpp v40, v43, v40 quad_perm:[3,3,3,3] row_mask:0xf bank_mask:0xf
    v_add_f32_dpp v44, v47, v44 quad_perm:[3,3,3,3] row_mask:0xf bank_mask:0xf
    v_add_f32_dpp v48, v51, v48 quad_perm:[3,3,3,3] row_mask:0xf bank_mask:0xf
    v_add_f32_dpp v52, v55, v52 quad_perm:[3,3,3,3] row_mask:0xf bank_mask:0xf
    v_fma_f32 v41, v40, s65, v7
    v_fma_f32 v45, v44, s65, v7
    v_fma_f32 v49, v48, s65, v7
    v_fma_f32 v53, v52, s65, v7
    v_max3_f32 v12, v41, v45, v49
    v_max_f32 v12, v12, v53
    v_cmp_lt_f32 vcc, 0, v12
    s_cbranch_vccnz L_resc_5
L_back_6:
    v_exp_f32 v41, v41
    v_exp_f32 v45, v45
    v_exp_f32 v49, v49
    v_exp_f32 v53, v53
    v_add_f32 v8, v8, v41
    v_add_f32 v8, v8, v45
    v_add_f32 v8, v8, v49
    v_add_f32 v8, v8, v53
    v_cvt_pk_bf16_f32 v41, v41, v41
    v_cvt_pk_bf16_f32 v45, v45, v45
    v_cvt_pk_bf16_f32 v49, v49, v49
    v_cvt_pk_bf16_f32 v53, v53, v53
    v_and_b32 v42, v41, v3
    v_and_b32 v43, v41, v4
    v_and_b32 v46, v45, v3
    v_and_b32 v47, v45, v4
    v_and_b32 v50, v49, v3
    v_and_b32 v51, v49, v4
    v_and_b32 v54, v53, v3
    v_and_b32 v55, v53, v4
    v_mfma_f32_16x16x16_bf16 v[32:35], v[42:43], v[136:137], v[32:35]
    v_mfma_f32_16x16x16_bf16 v[36:39], v[42:43], v[138:139], v[36:39]
    v_mfma_f32_16x16x16_bf16 v[32:35], v[46:47], v[140:141], v[32:35]
    v_mfma_f32_16x16x16_bf16 v[36:39], v[46:47], v[142:143], v[36:39]
    v_mfma_f32_16x16x16_bf16 v[32:35], v[50:51], v[144:145], v[32:35]
    v_mfma_f32_16x16x16_bf16 v[36:39], v[50:51], v[146:147], v[36:39]
    v_mfma_f32_16x16x16_bf16 v[32:35], v[54:55], v[148:149], v[32:35]
    v_mfma_f32_16x16x16_bf16 v[36:39], v[54:55], v[150:151], v[36:39]
    s_mov_b32 s71, 15
L_loopA:
    s_and_b32 s6, s73, 127
    s_lshl_b32 s6, s6, 12
    s_add_u32 s12, s6, s64
    s_add_u32 s73, s73, 4
    s_waitcnt vmcnt(0)
    v_mfma_f32_16x16x32_bf16 v[40:43], v[120:123], v[20:23], 0
    v_mfma_f32_16x16x32_bf16 v[44:47], v[124:127], v[20:23], 0
    v_mfma_f32_16x16x32_bf16 v[48:51], v[128:131], v[20:23], 0
    v_mfma_f32_16x16x32_bf16 v[52:55], v[132:135], v[20:23], 0
    buffer_load_dwordx4 v[120:123], v1, s[52:55], s12 offen offset:0 nt
    buffer_load_dwordx4 v[124:127], v1, s[52:55], s12 offen offset:1024 nt
    buffer_load_dwordx4 v[128:131], v1, s[52:55], s12 offen offset:2048 nt
    buffer_load_dwordx4 v[132:135], v1, s[52:55], s12 offen offset:3072 nt
    buffer_load_dwordx4 v[136:139], v2, s[56:59], s12 offen offset:0 nt
    buffer_load_dwordx4 v[140:143], v2, s[56:59], s12 offen offset:1024 nt
    buffer_load_dwordx4 v[144:147], v2, s[56:59], s12 offen offset:2048 nt
    buffer_load_dwordx4 v[148:151], v2, s[56:59], s12 offen offset:3072 nt
    v_mov_b32_dpp v40, v40 quad_perm:[0,0,0,0] row_mask:0xf bank_mask:0xf
    v_mov_b32_dpp v44, v44 quad_perm:[0,0,0,0] row_mask:0xf bank_mask:0xf
    v_mov_b32_dpp v48, v48 quad_perm:[0,0,0,0] row_mask:0xf bank_mask:0xf
    v_mov_b32_dpp v52, v52 quad_perm:[0,0,0,0] row_mask:0xf bank_mask:0xf
    v_add_f32_dpp v40, v41, v40 quad_perm:[1,1,1,1] row_mask:0xf bank_mask:0xf
    v_add_f32_dpp v44, v45, v44 quad_perm:[1,1,1,1] row_mask:0xf bank_mask:0xf
    v_add_f32_dpp v48, v49, v48 quad_perm:[1,1,1,1] row_mask:0xf bank_mask:0xf
    v_add_f32_dpp v52, v53, v52 quad_perm:[1,1,1,1] row_mask:0xf bank_mask:0xf
    v_add_f32_dpp v40, v42, v40 quad_perm:[2,2,2,2] row_mask:0xf bank_mask:0xf
    v_add_f32_dpp v44, v46, v44 quad_perm:[2,2,2,2] row_mask:0xf bank_mask:0xf
    v_add_f32_dpp v48, v50, v48 quad_perm:[2,2,2,2] row_mask:0xf bank_mask:0xf
    v_add_f32_dpp v52, v54, v52 quad_perm:[2,2,2,2] row_mask:0xf bank_mask:0xf
    v_add_f32_dpp v40, v43, v40 quad_perm:[3,3,3,3] row_mask:0xf bank_mask:0xf
    v_add_f32_dpp v44, v47, v44 quad_perm:[3,3,3,3] row_mask:0xf bank_mask:0xf
    v_add_f32_dpp v48, v51, v48 quad_perm:[3,3,3,3] row_mask:0xf bank_mask:0xf
    v_add_f32_dpp v52, v55, v52 quad_perm:[3,3,3,3] row_mask:0xf bank_mask:0xf
    v_fma_f32 v41, v40, s65, v7
    v_fma_f32 v45, v44, s65, v7
    v_fma_f32 v49, v48, s65, v7
    v_fma_f32 v53, v52, s65, v7
    v_max3_f32 v12, v41, v45, v49
    v_max_f32 v12, v12, v53
    v_cmp_lt_f32 vcc, 0, v12
    s_cbranch_vccnz L_resc_7
L_back_8:
    v_exp_f32 v41, v41
    v_exp_f32 v45, v45
    v_exp_f32 v49, v49
    v_exp_f32 v53, v53
    v_add_f32 v8, v8, v41
    v_add_f32 v8, v8, v45
    v_add_f32 v8, v8, v49
    v_add_f32 v8, v8, v53
    v_cvt_pk_bf16_f32 v41, v41, v41
    v_cvt_pk_bf16_f32 v45, v45, v45
    v_cvt_pk_bf16_f32 v49, v49, v49
    v_cvt_pk_bf16_f32 v53, v53, v53
    v_and_b32 v42, v41, v3
    v_and_b32 v43, v41, v4
    v_and_b32 v46, v45, v3
    v_and_b32 v47, v45, v4
    v_and_b32 v50, v49, v3
    v_and_b32 v51, v49, v4
    v_and_b32 v54, v53, v3
    v_and_b32 v55, v53, v4
    v_mfma_f32_16x16x16_bf16 v[32:35], v[42:43], v[168:169], v[32:35]
    v_mfma_f32_16x16x16_bf16 v[36:39], v[42:43], v[170:171], v[36:39]
    v_mfma_f32_16x16x16_bf16 v[32:35], v[46:47], v[172:173], v[32:35]
    v_mfma_f32_16x16x16_bf16 v[36:39], v[46:47], v[174:175], v[36:39]
    v_mfma_f32_16x16x16_bf16 v[32:35], v[50:51], v[176:177], v[32:35]
    v_mfma_f32_16x16x16_bf16 v[36:39], v[50:51], v[178:179], v[36:39]
    v_mfma_f32_16x16x16_bf16 v[32:35], v[54:55], v[180:181], v[32:35]
    v_mfma_f32_16x16x16_bf16 v[36:39], v[54:55], v[182:183], v[36:39]
    s_and_b32 s6, s73, 127
    s_lshl_b32 s6, s6, 12
    s_add_u32 s13, s6, s64
    s_add_u32 s73, s73, 4
    s_waitcnt vmcnt(0)
    v_mfma_f32_16x16x32_bf16 v[40:43], v[120:123], v[20:23], 0
    v_mfma_f32_16x16x32_bf16 v[44:47], v[124:127], v[20:23], 0
    v_mfma_f32_16x16x32_bf16 v[48:51], v[128:131], v[20:23], 0
    v_mfma_f32_16x16x32_bf16 v[52:55], v[132:135], v[20:23], 0
    buffer_load_dwordx4 v[120:123], v1, s[52:55], s13 offen offset:0 nt
    buffer_load_dwordx4 v[124:127], v1, s[52:55], s13 offen offset:1024 nt
    buffer_load_dwordx4 v[128:131], v1, s[52:55], s13 offen offset:2048 nt
    buffer_load_dwordx4 v[132:135], v1, s[52:55], s13 offen offset:3072 nt
    buffer_load_dwordx4 v[168:171], v2, s[56:59], s13 offen offset:0 nt
    buffer_load_dwordx4 v[172:175], v2, s[56:59], s13 offen offset:1024 nt
    buffer_load_dwordx4 v[176:179], v2, s[56:59], s13 offen offset:2048 nt
    buffer_load_dwordx4 v[180:183], v2, s[56:59], s13 offen offset:3072 nt
    v_mov_b32_dpp v40, v40 quad_perm:[0,0,0,0] row_mask:0xf bank_mask:0xf
    v_mov_b32_dpp v44, v44 quad_perm:[0,0,0,0] row_mask:0xf bank_mask:0xf
    v_mov_b32_dpp v48, v48 quad_perm:[0,0,0,0] row_mask:0xf bank_mask:0xf
    v_mov_b32_dpp v52, v52 quad_perm:[0,0,0,0] row_mask:0xf bank_mask:0xf
    v_add_f32_dpp v40, v41, v40 quad_perm:[1,1,1,1] row_mask:0xf bank_mask:0xf
    v_add_f32_dpp v44, v45, v44 quad_perm:[1,1,1,1] row_mask:0xf bank_mask:0xf
    v_add_f32_dpp v48, v49, v48 quad_perm:[1,1,1,1] row_mask:0xf bank_mask:0xf
    v_add_f32_dpp v52, v53, v52 quad_perm:[1,1,1,1] row_mask:0xf bank_mask:0xf
    v_add_f32_dpp v40, v42, v40 quad_perm:[2,2,2,2] row_mask:0xf bank_mask:0xf
    v_add_f32_dpp v44, v46, v44 quad_perm:[2,2,2,2] row_mask:0xf bank_mask:0xf
    v_add_f32_dpp v48, v50, v48 quad_perm:[2,2,2,2] row_mask:0xf bank_mask:0xf
    v_add_f32_dpp v52, v54, v52 quad_perm:[2,2,2,2] row_mask:0xf bank_mask:0xf
    v_add_f32_dpp v40, v43, v40 quad_perm:[3,3,3,3] row_mask:0xf bank_mask:0xf
    v_add_f32_dpp v44, v47, v44 quad_perm:[3,3,3,3] row_mask:0xf bank_mask:0xf
    v_add_f32_dpp v48, v51, v48 quad_perm:[3,3,3,3] row_mask:0xf bank_mask:0xf
    v_add_f32_dpp v52, v55, v52 quad_perm:[3,3,3,3] row_mask:0xf bank_mask:0xf
    v_fma_f32 v41, v40, s65, v7
    v_fma_f32 v45, v44, s65, v7
    v_fma_f32 v49, v48, s65, v7
    v_fma_f32 v53, v52, s65, v7
    v_max3_f32 v12, v41, v45, v49
    v_max_f32 v12, v12, v53
    v_cmp_lt_f32 vcc, 0, v12
    s_cbranch_vccnz L_resc_9
L_back_10:
    v_exp_f32 v41, v41
    v_exp_f32 v45, v45
    v_exp_f32 v49, v49
    v_exp_f32 v53, v53
    v_add_f32 v8, v8, v41
    v_add_f32 v8, v8, v45
    v_add_f32 v8, v8, v49
    v_add_f32 v8, v8, v53
    v_cvt_pk_bf16_f32 v41, v41, v41
    v_cvt_pk_bf16_f32 v45, v45, v45
    v_cvt_pk_bf16_f32 v49, v49, v49
    v_cvt_pk_bf16_f32 v53, v53, v53
    v_and_b32 v42, v41, v3
    v_and_b32 v43, v41, v4
    v_and_b32 v46, v45, v3
    v_and_b32 v47, v45, v4
    v_and_b32 v50, v49, v3
    v_and_b32 v51, v49, v4
    v_and_b32 v54, v53, v3
    v_and_b32 v55, v53, v4
    v_mfma_f32_16x16x16_bf16 v[32:35], v[42:43], v[136:137], v[32:35]
    v_mfma_f32_16x16x16_bf16 v[36:39], v[42:43], v[138:139], v[36:39]
    v_mfma_f32_16x16x16_bf16 v[32:35], v[46:47], v[140:141], v[32:35]
    v_mfma_f32_16x16x16_bf16 v[36:39], v[46:47], v[142:143], v[36:39]
    v_mfma_f32_16x16x16_bf16 v[32:35], v[50:51], v[144:145], v[32:35]
    v_mfma_f32_16x16x16_bf16 v[36:39], v[50:51], v[146:147], v[36:39]
    v_mfma_f32_16x16x16_bf16 v[32:35], v[54:55], v[148:149], v[32:35]
    v_mfma_f32_16x16x16_bf16 v[36:39], v[54:55], v[150:151], v[36:39]
    s_sub_u32 s71, s71, 1
    s_cmp_lg_u32 s71, 0
    s_cbranch_scc1 L_loopA
    s_mov_b32 s62, s8
    s_waitcnt vmcnt(0)
    v_mfma_f32_16x16x32_bf16 v[40:43], v[120:123], v[20:23], 0
    v_mfma_f32_16x16x32_bf16 v[44:47], v[124:127], v[20:23], 0
    v_mfma_f32_16x16x32_bf16 v[48:51], v[128:131], v[20:23], 0
    v_mfma_f32_16x16x32_bf16 v[52:55], v[132:135], v[20:23], 0
    s_and_b32 s6, s62, 2047
    s_lshr_b32 s7, s6, 9
    s_lshl_b32 s7, s7, 26
    s_and_b32 s6, s6, 511
    s_lshl_b32 s6, s6, 12
    s_or_b32 s6, s6, s7
    s_or_b32 s10, s6, s63
    s_add_u32 s62, s62, 32
    s_and_b32 s6, s62, 2047
    s_lshr_b32 s7, s6, 9
    s_lshl_b32 s7, s7, 26
    s_and_b32 s6, s6, 511
    s_lshl_b32 s6, s6, 12
    s_or_b32 s6, s6, s7
    s_or_b32 s11, s6, s63
    s_add_u32 s62, s62, 32
    buffer_load_dwordx4 v[88:91], v2, s[48:51], s10 offen offset:0 nt
    buffer_load_dwordx4 v[92:95], v2, s[48:51], s10 offen offset:1024 nt
    buffer_load_dwordx4 v[96:99], v2, s[48:51], s10 offen offset:2048 nt
    buffer_load_dwordx4 v[100:103], v2, s[48:51], s10 offen offset:3072 nt
    buffer_load_dwordx4 v[104:107], v2, s[48:51], s11 offen offset:0 nt
    buffer_load_dwordx4 v[108:111], v2, s[48:51], s11 offen offset:1024 nt
    buffer_load_dwordx4 v[112:115], v2, s[48:51], s11 offen offset:2048 nt
    buffer_load_dwordx4 v[116:119], v2, s[48:51], s11 offen offset:3072 nt
    v_mov_b32_dpp v40, v40 quad_perm:[0,0,0,0] row_mask:0xf bank_mask:0xf
    v_mov_b32_dpp v44, v44 quad_perm:[0,0,0,0] row_mask:0xf bank_mask:0xf
    v_mov_b32_dpp v48, v48 quad_perm:[0,0,0,0] row_mask:0xf bank_mask:0xf
    v_mov_b32_dpp v52, v52 quad_perm:[0,0,0,0] row_mask:0xf bank_mask:0xf
    v_add_f32_dpp v40, v41, v40 quad_perm:[1,1,1,1] row_mask:0xf bank_mask:0xf
    v_add_f32_dpp v44, v45, v44 quad_perm:[1,1,1,1] row_mask:0xf bank_mask:0xf
    v_add_f32_dpp v48, v49, v48 quad_perm:[1,1,1,1] row_mask:0xf bank_mask:0xf
    v_add_f32_dpp v52, v53, v52 quad_perm:[1,1,1,1] row_mask:0xf bank_mask:0xf
    v_add_f32_dpp v40, v42, v40 quad_perm:[2,2,2,2] row_mask:0xf bank_mask:0xf
    v_add_f32_dpp v44, v46, v44 quad_perm:[2,2,2,2] row_mask:0xf bank_mask:0xf
    v_add_f32_dpp v48, v50, v48 quad_perm:[2,2,2,2] row_mask:0xf bank_mask:0xf
    v_add_f32_dpp v52, v54, v52 quad_perm:[2,2,2,2] row_mask:0xf bank_mask:0xf
    v_add_f32_dpp v40, v43, v40 quad_perm:[3,3,3,3] row_mask:0xf bank_mask:0xf
    v_add_f32_dpp v44, v47, v44 quad_perm:[3,3,3,3] row_mask:0xf bank_mask:0xf
    v_add_f32_dpp v48, v51, v48 quad_perm:[3,3,3,3] row_mask:0xf bank_mask:0xf
    v_add_f32_dpp v52, v55, v52 quad_perm:[3,3,3,3] row_mask:0xf bank_mask:0xf
    v_fma_f32 v41, v40, s65, v7
    v_fma_f32 v45, v44, s65, v7
    v_fma_f32 v49, v48, s65, v7
    v_fma_f32 v53, v52, s65, v7
    v_max3_f32 v12, v41, v45, v49
    v_max_f32 v12, v12, v53
    v_cmp_lt_f32 vcc, 0, v12
    s_cbranch_vccnz L_resc_11
L_back_12:
    v_exp_f32 v41, v41
    v_exp_f32 v45, v45
    v_exp_f32 v49, v49
    v_exp_f32 v53, v53
    v_add_f32 v8, v8, v41
    v_add_f32 v8, v8, v45
    v_add_f32 v8, v8, v49
    v_add_f32 v8, v8, v53
    v_cvt_pk_bf16_f32 v41, v41, v41
    v_cvt_pk_bf16_f32 v45, v45, v45
    v_cvt_pk_bf16_f32 v49, v49, v49
    v_cvt_pk_bf16_f32 v53, v53, v53
    v_and_b32 v42, v41, v3
    v_and_b32 v43, v41, v4
    v_and_b32 v46, v45, v3
    v_and_b32 v47, v45, v4
    v_and_b32 v50, v49, v3
    v_and_b32 v51, v49, v4
    v_and_b32 v54, v53, v3
    v_and_b32 v55, v53, v4
    v_mfma_f32_16x16x16_bf16 v[32:35], v[42:43], v[168:169], v[32:35]
    v_mfma_f32_16x16x16_bf16 v[36:39], v[42:43], v[170:171], v[36:39]
    v_mfma_f32_16x16x16_bf16 v[32:35], v[46:47], v[172:173], v[32:35]
    v_mfma_f32_16x16x16_bf16 v[36:39], v[46:47], v[174:175], v[36:39]
    v_mfma_f32_16x16x16_bf16 v[32:35], v[50:51], v[176:177], v[32:35]
    v_mfma_f32_16x16x16_bf16 v[36:39], v[50:51], v[178:179], v[36:39]
    v_mfma_f32_16x16x16_bf16 v[32:35], v[54:55], v[180:181], v[32:35]
    v_mfma_f32_16x16x16_bf16 v[36:39], v[54:55], v[182:183], v[36:39]
    v_mov_b32 v13, v8
    s_nop 1
    v_permlane16_swap_b32 v8, v13
    s_nop 1
    v_add_f32 v8, v8, v13
    v_mov_b32 v13, v8
    s_nop 1
    v_permlane32_swap_b32 v8, v13
    s_nop 1
    v_add_f32 v8, v8, v13
    s_lshl_b32 s6, s3, 11
    v_add_u32 v12, s6, v2
    s_lshl_b32 s6, s3, 5
    v_and_b32 v13, 12, v0
    v_lshl_add_u32 v13, v13, 1, s6
    ds_write_b128 v12, v[32:35] offset:8192
    ds_write_b128 v12, v[36:39] offset:9216
    v_add_u32 v13, 2368, v13
    ds_write2_b32 v13, v7, v8 offset0:0 offset1:1
    s_waitcnt lgkmcnt(0)
    v_mov_b32 v12, 2052
    v_mov_b32 v13, 1
    ds_add_u32 v12, v13
L_v1_start:
    s_add_u32 s6, s74, 0
    v_lshl_add_u32 v15, v0, 2, s6
    s_mov_b32 s76, s8
    s_mov_b32 s71, 6
L_v1:
    ds_read_b32 v13, v15
    ds_read_b32 v14, v15 offset:256
    v_add_u32 v15, 512, v15
    s_waitcnt vmcnt(0)
    s_and_b32 s6, s62, 2047
    s_lshr_b32 s7, s6, 9
    s_lshl_b32 s7, s7, 26
    s_and_b32 s6, s6, 511
    s_lshl_b32 s6, s6, 12
    s_or_b32 s6, s6, s7
    s_or_b32 s10, s6, s63
    s_add_u32 s62, s62, 32
    s_and_b32 s6, s62, 2047
    s_lshr_b32 s7, s6, 9
    s_lshl_b32 s7, s7, 26
    s_and_b32 s6, s6, 511
    s_lshl_b32 s6, s6, 12
    s_or_b32 s6, s6, s7
    s_or_b32 s11, s6, s63
    s_add_u32 s62, s62, 32
    buffer_load_dwordx4 v[56:59], v2, s[48:51], s10 offen offset:0 nt
    buffer_load_dwordx4 v[60:63], v2, s[48:51], s10 offen offset:1024 nt
    buffer_load_dwordx4 v[64:67], v2, s[48:51], s10 offen offset:2048 nt
    buffer_load_dwordx4 v[68:71], v2, s[48:51], s10 offen offset:3072 nt
    buffer_load_dwordx4 v[72:75], v2, s[48:51], s11 offen offset:0 nt
    buffer_load_dwordx4 v[76:79], v2, s[48:51], s11 offen offset:1024 nt
    buffer_load_dwordx4 v[80:83], v2, s[48:51], s11 offen offset:2048 nt
    buffer_load_dwordx4 v[84:87], v2, s[48:51], s11 offen offset:3072 nt
    s_waitcnt lgkmcnt(0)
    s_bfe_u32 s6, s76, 0x20009
    s_lshl_b32 s6, s6, 2
    s_lshl_b64 s[66:67], s[68:69], s6
    s_add_u32 s76, s76, 32
    v_cndmask_b32 v9, v10, v5, s[66:67]
    v_mov_b32_dpp v40, v13 quad_perm:[0,0,0,0] row_mask:0xf bank_mask:0xf
    v_mov_b32_dpp v44, v13 quad_perm:[1,1,1,1] row_mask:0xf bank_mask:0xf
    v_mov_b32_dpp v48, v13 quad_perm:[2,2,2,2] row_mask:0xf bank_mask:0xf
    v_mov_b32_dpp v52, v13 quad_perm:[3,3,3,3] row_mask:0xf bank_mask:0xf
    v_fma_f32 v41, v40, s65, v9
    v_fma_f32 v45, v44, s65, v9
    v_fma_f32 v49, v48, s65, v9
    v_fma_f32 v53, v52, s65, v9
    v_exp_f32 v41, v41
    v_exp_f32 v45, v45
    v_exp_f32 v49, v49
    v_exp_f32 v53, v53
    v_add_f32 v6, v6, v41
    v_add_f32 v6, v6, v45
    v_add_f32 v6, v6, v49
    v_add_f32 v6, v6, v53
    v_cvt_pk_bf16_f32 v41, v41, v41
    v_cvt_pk_bf16_f32 v45, v45, v45
    v_cvt_pk_bf16_f32 v49, v49, v49
    v_cvt_pk_bf16_f32 v53, v53, v53
    v_and_b32 v42, v41, v3
    v_and_b32 v43, v41, v4
    v_and_b32 v46, v45, v3
    v_and_b32 v47, v45, v4
    v_and_b32 v50, v49, v3
    v_and_b32 v51, v49, v4
    v_and_b32 v54, v53, v3
    v_and_b32 v55, v53, v4
    v_mfma_f32_16x16x16_bf16 v[24:27], v[42:43], v[88:89], v[24:27]
    v_mfma_f32_16x16x16_bf16 v[28:31], v[42:43], v[90:91], v[28:31]
    v_mfma_f32_16x16x16_bf16 v[24:27], v[46:47], v[92:93], v[24:27]
    v_mfma_f32_16x16x16_bf16 v[28:31], v[46:47], v[94:95], v[28:31]
    v_mfma_f32_16x16x16_bf16 v[24:27], v[50:51], v[96:97], v[24:27]
    v_mfma_f32_16x16x16_bf16 v[28:31], v[50:51], v[98:99], v[28:31]
    v_mfma_f32_16x16x16_bf16 v[24:27], v[54:55], v[100:101], v[24:27]
    v_mfma_f32_16x16x16_bf16 v[28:31], v[54:55], v[102:103], v[28:31]
    s_bfe_u32 s6, s76, 0x20009
    s_lshl_b32 s6, s6, 2
    s_lshl_b64 s[66:67], s[68:69], s6
    s_add_u32 s76, s76, 32
    v_cndmask_b32 v9, v10, v5, s[66:67]
    v_mov_b32_dpp v40, v14 quad_perm:[0,0,0,0] row_mask:0xf bank_mask:0xf
    v_mov_b32_dpp v44, v14 quad_perm:[1,1,1,1] row_mask:0xf bank_mask:0xf
    v_mov_b32_dpp v48, v14 quad_perm:[2,2,2,2] row_mask:0xf bank_mask:0xf
    v_mov_b32_dpp v52, v14 quad_perm:[3,3,3,3] row_mask:0xf bank_mask:0xf
    v_fma_f32 v41, v40, s65, v9
    v_fma_f32 v45, v44, s65, v9
    v_fma_f32 v49, v48, s65, v9
    v_fma_f32 v53, v52, s65, v9
    v_exp_f32 v41, v41
    v_exp_f32 v45, v45
    v_exp_f32 v49, v49
    v_exp_f32 v53, v53
    v_add_f32 v6, v6, v41
    v_add_f32 v6, v6, v45
    v_add_f32 v6, v6, v49
    v_add_f32 v6, v6, v53
    v_cvt_pk_bf16_f32 v41, v41, v41
    v_cvt_pk_bf16_f32 v45, v45, v45
    v_cvt_pk_bf16_f32 v49, v49, v49
    v_cvt_pk_bf16_f32 v53, v53, v53
    v_and_b32 v42, v41, v3
    v_and_b32 v43, v41, v4
    v_and_b32 v46, v45, v3
    v_and_b32 v47, v45, v4
    v_and_b32 v50, v49, v3
    v_and_b32 v51, v49, v4
    v_and_b32 v54, v53, v3
    v_and_b32 v55, v53, v4
    v_mfma_f32_16x16x16_bf16 v[24:27], v[42:43], v[104:105], v[24:27]
    v_mfma_f32_16x16x16_bf16 v[28:31], v[42:43], v[106:107], v[28:31]
    v_mfma_f32_16x16x16_bf16 v[24:27], v[46:47], v[108:109], v[24:27]
    v_mfma_f32_16x16x16_bf16 v[28:31], v[46:47], v[110:111], v[28:31]
    v_mfma_f32_16x16x16_bf16 v[24:27], v[50:51], v[112:113], v[24:27]
    v_mfma_f32_16x16x16_bf16 v[28:31], v[50:51], v[114:115], v[28:31]
    v_mfma_f32_16x16x16_bf16 v[24:27], v[54:55], v[116:117], v[24:27]
    v_mfma_f32_16x16x16_bf16 v[28:31], v[54:55], v[118:119], v[28:31]
    ds_read_b32 v13, v15
    ds_read_b32 v14, v15 offset:256
    v_add_u32 v15, 512, v15
    s_waitcnt vmcnt(0)
    s_and_b32 s6, s62, 2047
    s_lshr_b32 s7, s6, 9
    s_lshl_b32 s7, s7, 26
    s_and_b32 s6, s6, 511
    s_lshl_b32 s6, s6, 12
    s_or_b32 s6, s6, s7
    s_or_b32 s10, s6, s63
    s_add_u32 s62, s62, 32
    s_and_b32 s6, s62, 2047
    s_lshr_b32 s7, s6, 9
    s_lshl_b32 s7, s7, 26
    s_and_b32 s6, s6, 511
    s_lshl_b32 s6, s6, 12
    s_or_b32 s6, s6, s7
    s_or_b32 s11, s6, s63
    s_add_u32 s62, s62, 32
    buffer_load_dwordx4 v[88:91], v2, s[48:51], s10 offen offset:0 nt
    buffer_load_dwordx4 v[92:95], v2, s[48:51], s10 offen offset:1024 nt
    buffer_load_dwordx4 v[96:99], v2, s[48:51], s10 offen offset:2048 nt
    buffer_load_dwordx4 v[100:103], v2, s[48:51], s10 offen offset:3072 nt
    buffer_load_dwordx4 v[104:107], v2, s[48:51], s11 offen offset:0 nt
    buffer_load_dwordx4 v[108:111], v2, s[48:51], s11 offen offset:1024 nt
    buffer_load_dwordx4 v[112:115], v2, s[48:51], s11 offen offset:2048 nt
    buffer_load_dwordx4 v[116:119], v2, s[48:51], s11 offen offset:3072 nt
    s_waitcnt lgkmcnt(0)
    s_bfe_u32 s6, s76, 0x20009
    s_lshl_b32 s6, s6, 2
    s_lshl_b64 s[66:67], s[68:69], s6
    s_add_u32 s76, s76, 32
    v_cndmask_b32 v9, v10, v5, s[66:67]
    v_mov_b32_dpp v40, v13 quad_perm:[0,0,0,0] row_mask:0xf bank_mask:0xf
    v_mov_b32_dpp v44, v13 quad_perm:[1,1,1,1] row_mask:0xf bank_mask:0xf
    v_mov_b32_dpp v48, v13 quad_perm:[2,2,2,2] row_mask:0xf bank_mask:0xf
    v_mov_b32_dpp v52, v13 quad_perm:[3,3,3,3] row_mask:0xf bank_mask:0xf
    v_fma_f32 v41, v40, s65, v9
    v_fma_f32 v45, v44, s65, v9
    v_fma_f32 v49, v48, s65, v9
    v_fma_f32 v53, v52, s65, v9
    v_exp_f32 v41, v41
    v_exp_f32 v45, v45
    v_exp_f32 v49, v49
    v_exp_f32 v53, v53
    v_add_f32 v6, v6, v41
    v_add_f32 v6, v6, v45
    v_add_f32 v6, v6, v49
    v_add_f32 v6, v6, v53
    v_cvt_pk_bf16_f32 v41, v41, v41
    v_cvt_pk_bf16_f32 v45, v45, v45
    v_cvt_pk_bf16_f32 v49, v49, v49
    v_cvt_pk_bf16_f32 v53, v53, v53
    v_and_b32 v42, v41, v3
    v_and_b32 v43, v41, v4
    v_and_b32 v46, v45, v3
    v_and_b32 v47, v45, v4
    v_and_b32 v50, v49, v3
    v_and_b32 v51, v49, v4
    v_and_b32 v54, v53, v3
    v_and_b32 v55, v53, v4
    v_mfma_f32_16x16x16_bf16 v[24:27], v[42:43], v[56:57], v[24:27]
    v_mfma_f32_16x16x16_bf16 v[28:31], v[42:43], v[58:59], v[28:31]
    v_mfma_f32_16x16x16_bf16 v[24:27], v[46:47], v[60:61], v[24:27]
    v_mfma_f32_16x16x16_bf16 v[28:31], v[46:47], v[62:63], v[28:31]
    v_mfma_f32_16x16x16_bf16 v[24:27], v[50:51], v[64:65], v[24:27]
    v_mfma_f32_16x16x16_bf16 v[28:31], v[50:51], v[66:67], v[28:31]
    v_mfma_f32_16x16x16_bf16 v[24:27], v[54:55], v[68:69], v[24:27]
    v_mfma_f32_16x16x16_bf16 v[28:31], v[54:55], v[70:71], v[28:31]
    s_bfe_u32 s6, s76, 0x20009
    s_lshl_b32 s6, s6, 2
    s_lshl_b64 s[66:67], s[68:69], s6
    s_add_u32 s76, s76, 32
    v_cndmask_b32 v9, v10, v5, s[66:67]
    v_mov_b32_dpp v40, v14 quad_perm:[0,0,0,0] row_mask:0xf bank_mask:0xf
    v_mov_b32_dpp v44, v14 quad_perm:[1,1,1,1] row_mask:0xf bank_mask:0xf
    v_mov_b32_dpp v48, v14 quad_perm:[2,2,2,2] row_mask:0xf bank_mask:0xf
    v_mov_b32_dpp v52, v14 quad_perm:[3,3,3,3] row_mask:0xf bank_mask:0xf
    v_fma_f32 v41, v40, s65, v9
    v_fma_f32 v45, v44, s65, v9
    v_fma_f32 v49, v48, s65, v9
    v_fma_f32 v53, v52, s65, v9
    v_exp_f32 v41, v41
    v_exp_f32 v45, v45
    v_exp_f32 v49, v49
    v_exp_f32 v53, v53
    v_add_f32 v6, v6, v41
    v_add_f32 v6, v6, v45
    v_add_f32 v6, v6, v49
    v_add_f32 v6, v6, v53
    v_cvt_pk_bf16_f32 v41, v41, v41
    v_cvt_pk_bf16_f32 v45, v45, v45
    v_cvt_pk_bf16_f32 v49, v49, v49
    v_cvt_pk_bf16_f32 v53, v53, v53
    v_and_b32 v42, v41, v3
    v_and_b32 v43, v41, v4
    v_and_b32 v46, v45, v3
    v_and_b32 v47, v45, v4
    v_and_b32 v50, v49, v3
    v_and_b32 v51, v49, v4
    v_and_b32 v54, v53, v3
    v_and_b32 v55, v53, v4
    v_mfma_f32_16x16x16_bf16 v[24:27], v[42:43], v[72:73], v[24:27]
    v_mfma_f32_16x16x16_bf16 v[28:31], v[42:43], v[74:75], v[28:31]
    v_mfma_f32_16x16x16_bf16 v[24:27], v[46:47], v[76:77], v[24:27]
    v_mfma_f32_16x16x16_bf16 v[28:31], v[46:47], v[78:79], v[28:31]
    v_mfma_f32_16x16x16_bf16 v[24:27], v[50:51], v[80:81], v[24:27]
    v_mfma_f32_16x16x16_bf16 v[28:31], v[50:51], v[82:83], v[28:31]
    v_mfma_f32_16x16x16_bf16 v[24:27], v[54:55], v[84:85], v[24:27]
    v_mfma_f32_16x16x16_bf16 v[28:31], v[54:55], v[86:87], v[28:31]
    s_sub_u32 s71, s71, 1
    s_cmp_lg_u32 s71, 0
    s_cbranch_scc1 L_v1
    s_add_u32 s72, s72, 1728
    s_waitcnt lgkmcnt(0)
    s_sub_u32 s70, s70, s75
    s_cmp_ge_u32 s70, 320
    s_cbranch_scc1 L_vlast
    s_add_u32 s62, s72, s70
    ds_read_b32 v13, v15
    ds_read_b32 v14, v15 offset:256
    v_add_u32 v15, 512, v15
    s_waitcnt vmcnt(0)
    s_and_b32 s6, s62, 2047
    s_lshr_b32 s7, s6, 9
    s_lshl_b32 s14, s7, 2
    s_lshl_b32 s7, s7, 26
    s_and_b32 s6, s6, 511
    s_lshl_b32 s6, s6, 12
    s_or_b32 s6, s6, s7
    s_or_b32 s12, s6, s63
    buffer_load_dwordx4 v[120:123], v1, s[44:47], s12 offen offset:0 nt
    buffer_load_dwordx4 v[124:127], v1, s[44:47], s12 offen offset:1024 nt
    buffer_load_dwordx4 v[128:131], v1, s[44:47], s12 offen offset:2048 nt
    buffer_load_dwordx4 v[132:135], v1, s[44:47], s12 offen offset:3072 nt
    buffer_load_dwordx4 v[136:139], v2, s[48:51], s12 offen offset:0 nt
    buffer_load_dwordx4 v[140:143], v2, s[48:51], s12 offen offset:1024 nt
    buffer_load_dwordx4 v[144:147], v2, s[48:51], s12 offen offset:2048 nt
    buffer_load_dwordx4 v[148:151], v2, s[48:51], s12 offen offset:3072 nt
    s_waitcnt lgkmcnt(0)
    s_bfe_u32 s6, s76, 0x20009
    s_lshl_b32 s6, s6, 2
    s_lshl_b64 s[66:67], s[68:69], s6
    s_add_u32 s76, s76, 32
    v_cndmask_b32 v9, v10, v5, s[66:67]
    v_mov_b32_dpp v40, v13 quad_perm:[0,0,0,0] row_mask:0xf bank_mask:0xf
    v_mov_b32_dpp v44, v13 quad_perm:[1,1,1,1] row_mask:0xf bank_mask:0xf
    v_mov_b32_dpp v48, v13 quad_perm:[2,2,2,2] row_mask:0xf bank_mask:0xf
    v_mov_b32_dpp v52, v13 quad_perm:[3,3,3,3] row_mask:0xf bank_mask:0xf
    v_fma_f32 v41, v40, s65, v9
    v_fma_f32 v45, v44, s65, v9
    v_fma_f32 v49, v48, s65, v9
    v_fma_f32 v53, v52, s65, v9
    v_exp_f32 v41, v41
    v_exp_f32 v45, v45
    v_exp_f32 v49, v49
    v_exp_f32 v53, v53
    v_add_f32 v6, v6, v41
    v_add_f32 v6, v6, v45
    v_add_f32 v6, v6, v49
    v_add_f32 v6, v6, v53
    v_cvt_pk_bf16_f32 v41, v41, v41
    v_cvt_pk_bf16_f32 v45, v45, v45
    v_cvt_pk_bf16_f32 v49, v49, v49
    v_cvt_pk_bf16_f32 v53, v53, v53
    v_and_b32 v42, v41, v3
    v_and_b32 v43, v41, v4
    v_and_b32 v46, v45, v3
    v_and_b32 v47, v45, v4
    v_and_b32 v50, v49, v3
    v_and_b32 v51, v49, v4
    v_and_b32 v54, v53, v3
    v_and_b32 v55, v53, v4
    v_mfma_f32_16x16x16_bf16 v[24:27], v[42:43], v[88:89], v[24:27]
    v_mfma_f32_16x16x16_bf16 v[28:31], v[42:43], v[90:91], v[28:31]
    v_mfma_f32_16x16x16_bf16 v[24:27], v[46:47], v[92:93], v[24:27]
    v_mfma_f32_16x16x16_bf16 v[28:31], v[46:47], v[94:95], v[28:31]
    v_mfma_f32_16x16x16_bf16 v[24:27], v[50:51], v[96:97], v[24:27]
    v_mfma_f32_16x16x16_bf16 v[28:31], v[50:51], v[98:99], v[28:31]
    v_mfma_f32_16x16x16_bf16 v[24:27], v[54:55], v[100:101], v[24:27]
    v_mfma_f32_16x16x16_bf16 v[28:31], v[54:55], v[102:103], v[28:31]
    s_bfe_u32 s6, s76, 0x20009
    s_lshl_b32 s6, s6, 2
    s_lshl_b64 s[66:67], s[68:69], s6
    s_add_u32 s76, s76, 32
    v_cndmask_b32 v9, v10, v5, s[66:67]
    v_mov_b32_dpp v40, v14 quad_perm:[0,0,0,0] row_mask:0xf bank_mask:0xf
    v_mov_b32_dpp v44, v14 quad_perm:[1,1,1,1] row_mask:0xf bank_mask:0xf
    v_mov_b32_dpp v48, v14 quad_perm:[2,2,2,2] row_mask:0xf bank_mask:0xf
    v_mov_b32_dpp v52, v14 quad_perm:[3,3,3,3] row_mask:0xf bank_mask:0xf
    v_fma_f32 v41, v40, s65, v9
    v_fma_f32 v45, v44, s65, v9
    v_fma_f32 v49, v48, s65, v9
    v_fma_f32 v53, v52, s65, v9
    v_exp_f32 v41, v41
    v_exp_f32 v45, v45
    v_exp_f32 v49, v49
    v_exp_f32 v53, v53
    v_add_f32 v6, v6, v41
    v_add_f32 v6, v6, v45
    v_add_f32 v6, v6, v49
    v_add_f32 v6, v6, v53
    v_cvt_pk_bf16_f32 v41, v41, v41
    v_cvt_pk_bf16_f32 v45, v45, v45
    v_cvt_pk_bf16_f32 v49, v49, v49
    v_cvt_pk_bf16_f32 v53, v53, v53
    v_and_b32 v42, v41, v3
    v_and_b32 v43, v41, v4
    v_and_b32 v46, v45, v3
    v_and_b32 v47, v45, v4
    v_and_b32 v50, v49, v3
    v_and_b32 v51, v49, v4
    v_and_b32 v54, v53, v3
    v_and_b32 v55, v53, v4
    v_mfma_f32_16x16x16_bf16 v[24:27], v[42:43], v[104:105], v[24:27]
    v_mfma_f32_16x16x16_bf16 v[28:31], v[42:43], v[106:107], v[28:31]
    v_mfma_f32_16x16x16_bf16 v[24:27], v[46:47], v[108:109], v[24:27]
    v_mfma_f32_16x16x16_bf16 v[28:31], v[46:47], v[110:111], v[28:31]
    v_mfma_f32_16x16x16_bf16 v[24:27], v[50:51], v[112:113], v[24:27]
    v_mfma_f32_16x16x16_bf16 v[28:31], v[50:51], v[114:115], v[28:31]
    v_mfma_f32_16x16x16_bf16 v[24:27], v[54:55], v[116:117], v[24:27]
    v_mfma_f32_16x16x16_bf16 v[28:31], v[54:55], v[118:119], v[28:31]
    s_mov_b32 s70, 1
    s_atomic_add s70, s[60:61], 0 glc
L_dyn:
    s_waitcnt vmcnt(0)
    v_mfma_f32_16x16x32_bf16 v[40:43], v[120:123], v[16:19], 0
    v_mfma_f32_16x16x32_bf16 v[44:47], v[124:127], v[16:19], 0
    v_mfma_f32_16x16x32_bf16 v[48:51], v[128:131], v[16:19], 0
    v_mfma_f32_16x16x32_bf16 v[52:55], v[132:135], v[16:19], 0
    s_lshl_b64 s[66:67], s[68:69], s14
    v_cndmask_b32 v9, v10, v5, s[66:67]
    s_waitcnt lgkmcnt(0)
    s_sub_u32 s70, s70, s75
    s_cmp_ge_u32 s70, 320
    s_cbranch_scc1 L_tail0
    s_add_u32 s62, s72, s70
    s_mov_b32 s70, 1
    s_atomic_add s70, s[60:61], 0 glc
    s_and_b32 s6, s62, 2047
    s_lshr_b32 s7, s6, 9
    s_lshl_b32 s15, s7, 2
    s_lshl_b32 s7, s7, 26
    s_and_b32 s6, s6, 511
    s_lshl_b32 s6, s6, 12
    s_or_b32 s6, s6, s7
    s_or_b32 s13, s6, s63
    buffer_load_dwordx4 v[120:123], v1, s[44:47], s13 offen offset:0 nt
    buffer_load_dwordx4 v[124:127], v1, s[44:47], s13 offen offset:1024 nt
    buffer_load_dwordx4 v[128:131], v1, s[44:47], s13 offen offset:2048 nt
    buffer_load_dwordx4 v[132:135], v1, s[44:47], s13 offen offset:3072 nt
    buffer_load_dwordx4 v[168:171], v2, s[48:51], s13 offen offset:0 nt
    buffer_load_dwordx4 v[172:175], v2, s[48:51], s13 offen offset:1024 nt
    buffer_load_dwordx4 v[176:179], v2, s[48:51], s13 offen offset:2048 nt
    buffer_load_dwordx4 v[180:183], v2, s[48:51], s13 offen offset:3072 nt
    v_mov_b32_dpp v40, v40 quad_perm:[0,0,0,0] row_mask:0xf bank_mask:0xf
    v_mov_b32_dpp v44, v44 quad_perm:[0,0,0,0] row_mask:0xf bank_mask:0xf
    v_mov_b32_dpp v48, v48 quad_perm:[0,0,0,0] row_mask:0xf bank_mask:0xf
    v_mov_b32_dpp v52, v52 quad_perm:[0,0,0,0] row_mask:0xf bank_mask:0xf
    v_add_f32_dpp v40, v41, v40 quad_perm:[1,1,1,1] row_mask:0xf bank_mask:0xf
    v_add_f32_dpp v44, v45, v44 quad_perm:[1,1,1,1] row_mask:0xf bank_mask:0xf
    v_add_f32_dpp v48, v49, v48 quad_perm:[1,1,1,1] row_mask:0xf bank_mask:0xf
    v_add_f32_dpp v52, v53, v52 quad_perm:[1,1,1,1] row_mask:0xf bank_mask:0xf
    v_add_f32_dpp v40, v42, v40 quad_perm:[2,2,2,2] row_mask:0xf bank_mask:0xf
    v_add_f32_dpp v44, v46, v44 quad_perm:[2,2,2,2] row_mask:0xf bank_mask:0xf
    v_add_f32_dpp v48, v50, v48 quad_perm:[2,2,2,2] row_mask:0xf bank_mask:0xf
    v_add_f32_dpp v52, v54, v52 quad_perm:[2,2,2,2] row_mask:0xf bank_mask:0xf
    v_add_f32_dpp v40, v43, v40 quad_perm:[3,3,3,3] row_mask:0xf bank_mask:0xf
    v_add_f32_dpp v44, v47, v44 quad_perm:[3,3,3,3] row_mask:0xf bank_mask:0xf
    v_add_f32_dpp v48, v51, v48 quad_perm:[3,3,3,3] row_mask:0xf bank_mask:0xf
    v_add_f32_dpp v52, v55, v52 quad_perm:[3,3,3,3] row_mask:0xf bank_mask:0xf
    v_fma_f32 v41, v40, s65, v9
    v_fma_f32 v45, v44, s65, v9
    v_fma_f32 v49, v48, s65, v9
    v_fma_f32 v53, v52, s65, v9
    v_max3_f32 v12, v41, v45, v49
    v_max_f32 v12, v12, v53
    v_cmp_lt_f32 vcc, 0, v12
    s_cbranch_vccnz L_resc_13
L_back_14:
    v_exp_f32 v41, v41
    v_exp_f32 v45, v45
    v_exp_f32 v49, v49
    v_exp_f32 v53, v53
    v_add_f32 v6, v6, v41
    v_add_f32 v6, v6, v45
    v_add_f32 v6, v6, v49
    v_add_f32 v6, v6, v53
    v_cvt_pk_bf16_f32 v41, v41, v41
    v_cvt_pk_bf16_f32 v45, v45, v45
    v_cvt_pk_bf16_f32 v49, v49, v49
    v_cvt_pk_bf16_f32 v53, v53, v53
    v_and_b32 v42, v41, v3
    v_and_b32 v43, v41, v4
    v_and_b32 v46, v45, v3
    v_and_b32 v47, v45, v4
    v_and_b32 v50, v49, v3
    v_and_b32 v51, v49, v4
    v_and_b32 v54, v53, v3
    v_and_b32 v55, v53, v4
    v_mfma_f32_16x16x16_bf16 v[24:27], v[42:43], v[136:137], v[24:27]
    v_mfma_f32_16x16x16_bf16 v[28:31], v[42:43], v[138:139], v[28:31]
    v_mfma_f32_16x16x16_bf16 v[24:27], v[46:47], v[140:141], v[24:27]
    v_mfma_f32_16x16x16_bf16 v[28:31], v[46:47], v[142:143], v[28:31]
    v_mfma_f32_16x16x16_bf16 v[24:27], v[50:51], v[144:145], v[24:27]
    v_mfma_f32_16x16x16_bf16 v[28:31], v[50:51], v[146:147], v[28:31]
    v_mfma_f32_16x16x16_bf16 v[24:27], v[54:55], v[148:149], v[24:27]
    v_mfma_f32_16x16x16_bf16 v[28:31], v[54:55], v[150:151], v[28:31]
    s_waitcnt vmcnt(0)
    v_mfma_f32_16x16x32_bf16 v[40:43], v[120:123], v[16:19], 0
    v_mfma_f32_16x16x32_bf16 v[44:47], v[124:127], v[16:19], 0
    v_mfma_f32_16x16x32_bf16 v[48:51], v[128:131], v[16:19], 0
    v_mfma_f32_16x16x32_bf16 v[52:55], v[132:135], v[16:19], 0
    s_lshl_b64 s[66:67], s[68:69], s15
    v_cndmask_b32 v9, v10, v5, s[66:67]
    s_waitcnt lgkmcnt(0)
    s_sub_u32 s70, s70, s75
    s_cmp_ge_u32 s70, 320
    s_cbranch_scc1 L_tail1
    s_add_u32 s62, s72, s70
    s_mov_b32 s70, 1
    s_atomic_add s70, s[60:61], 0 glc
    s_and_b32 s6, s62, 2047
    s_lshr_b32 s7, s6, 9
    s_lshl_b32 s14, s7, 2
    s_lshl_b32 s7, s7, 26
    s_and_b32 s6, s6, 511
    s_lshl_b32 s6, s6, 12
    s_or_b32 s6, s6, s7
    s_or_b32 s12, s6, s63
    buffer_load_dwordx4 v[120:123], v1, s[44:47], s12 offen offset:0 nt
    buffer_load_dwordx4 v[124:127], v1, s[44:47], s12 offen offset:1024 nt
    buffer_load_dwordx4 v[128:131], v1, s[44:47], s12 offen offset:2048 nt
    buffer_load_dwordx4 v[132:135], v1, s[44:47], s12 offen offset:3072 nt
    buffer_load_dwordx4 v[136:139], v2, s[48:51], s12 offen offset:0 nt
    buffer_load_dwordx4 v[140:143], v2, s[48:51], s12 offen offset:1024 nt
    buffer_load_dwordx4 v[144:147], v2, s[48:51], s12 offen offset:2048 nt
    buffer_load_dwordx4 v[148:151], v2, s[48:51], s12 offen offset:3072 nt
    v_mov_b32_dpp v40, v40 quad_perm:[0,0,0,0] row_mask:0xf bank_mask:0xf
    v_mov_b32_dpp v44, v44 quad_perm:[0,0,0,0] row_mask:0xf bank_mask:0xf
    v_mov_b32_dpp v48, v48 quad_perm:[0,0,0,0] row_mask:0xf bank_mask:0xf
    v_mov_b32_dpp v52, v52 quad_perm:[0,0,0,0] row_mask:0xf bank_mask:0xf
    v_add_f32_dpp v40, v41, v40 quad_perm:[1,1,1,1] row_mask:0xf bank_mask:0xf
    v_add_f32_dpp v44, v45, v44 quad_perm:[1,1,1,1] row_mask:0xf bank_mask:0xf
    v_add_f32_dpp v48, v49, v48 quad_perm:[1,1,1,1] row_mask:0xf bank_mask:0xf
    v_add_f32_dpp v52, v53, v52 quad_perm:[1,1,1,1] row_mask:0xf bank_mask:0xf
    v_add_f32_dpp v40, v42, v40 quad_perm:[2,2,2,2] row_mask:0xf bank_mask:0xf
    v_add_f32_dpp v44, v46, v44 quad_perm:[2,2,2,2] row_mask:0xf bank_mask:0xf
    v_add_f32_dpp v48, v50, v48 quad_perm:[2,2,2,2] row_mask:0xf bank_mask:0xf
    v_add_f32_dpp v52, v54, v52 quad_perm:[2,2,2,2] row_mask:0xf bank_mask:0xf
    v_add_f32_dpp v40, v43, v40 quad_perm:[3,3,3,3] row_mask:0xf bank_mask:0xf
    v_add_f32_dpp v44, v47, v44 quad_perm:[3,3,3,3] row_mask:0xf bank_mask:0xf
    v_add_f32_dpp v48, v51, v48 quad_perm:[3,3,3,3] row_mask:0xf bank_mask:0xf
    v_add_f32_dpp v52, v55, v52 quad_perm:[3,3,3,3] row_mask:0xf bank_mask:0xf
    v_fma_f32 v41, v40, s65, v9
    v_fma_f32 v45, v44, s65, v9
    v_fma_f32 v49, v48, s65, v9
    v_fma_f32 v53, v52, s65, v9
    v_max3_f32 v12, v41, v45, v49
    v_max_f32 v12, v12, v53
    v_cmp_lt_f32 vcc, 0, v12
    s_cbranch_vccnz L_resc_15
L_back_16:
    v_exp_f32 v41, v41
    v_exp_f32 v45, v45
    v_exp_f32 v49, v49
    v_exp_f32 v53, v53
    v_add_f32 v6, v6, v41
    v_add_f32 v6, v6, v45
    v_add_f32 v6, v6, v49
    v_add_f32 v6, v6, v53
    v_cvt_pk_bf16_f32 v41, v41, v41
    v_cvt_pk_bf16_f32 v45, v45, v45
    v_cvt_pk_bf16_f32 v49, v49, v49
    v_cvt_pk_bf16_f32 v53, v53, v53
    v_and_b32 v42, v41, v3
    v_and_b32 v43, v41, v4
    v_and_b32 v46, v45, v3
    v_and_b32 v47, v45, v4
    v_and_b32 v50, v49, v3
    v_and_b32 v51, v49, v4
    v_and_b32 v54, v53, v3
    v_and_b32 v55, v53, v4
    v_mfma_f32_16x16x16_bf16 v[24:27], v[42:43], v[168:169], v[24:27]
    v_mfma_f32_16x16x16_bf16 v[28:31], v[42:43], v[170:171], v[28:31]
    v_mfma_f32_16x16x16_bf16 v[24:27], v[46:47], v[172:173], v[24:27]
    v_mfma_f32_16x16x16_bf16 v[28:31], v[46:47], v[174:175], v[28:31]
    v_mfma_f32_16x16x16_bf16 v[24:27], v[50:51], v[176:177], v[24:27]
    v_mfma_f32_16x16x16_bf16 v[28:31], v[50:51], v[178:179], v[28:31]
    v_mfma_f32_16x16x16_bf16 v[24:27], v[54:55], v[180:181], v[24:27]
    v_mfma_f32_16x16x16_bf16 v[28:31], v[54:55], v[182:183], v[28:31]
    s_branch L_dyn
L_vlast:
    ds_read_b32 v13, v15
    ds_read_b32 v14, v15 offset:256
    v_add_u32 v15, 512, v15
    s_waitcnt vmcnt(0)
    s_waitcnt lgkmcnt(0)
    s_bfe_u32 s6, s76, 0x20009
    s_lshl_b32 s6, s6, 2
    s_lshl_b64 s[66:67], s[68:69], s6
    s_add_u32 s76, s76, 32
    v_cndmask_b32 v9, v10, v5, s[66:67]
    v_mov_b32_dpp v40, v13 quad_perm:[0,0,0,0] row_mask:0xf bank_mask:0xf
    v_mov_b32_dpp v44, v13 quad_perm:[1,1,1,1] row_mask:0xf bank_mask:0xf
    v_mov_b32_dpp v48, v13 quad_perm:[2,2,2,2] row_mask:0xf bank_mask:0xf
    v_mov_b32_dpp v52, v13 quad_perm:[3,3,3,3] row_mask:0xf bank_mask:0xf
    v_fma_f32 v41, v40, s65, v9
    v_fma_f32 v45, v44, s65, v9
    v_fma_f32 v49, v48, s65, v9
    v_fma_f32 v53, v52, s65, v9
    v_exp_f32 v41, v41
    v_exp_f32 v45, v45
    v_exp_f32 v49, v49
    v_exp_f32 v53, v53
    v_add_f32 v6, v6, v41
    v_add_f32 v6, v6, v45
    v_add_f32 v6, v6, v49
    v_add_f32 v6, v6, v53
    v_cvt_pk_bf16_f32 v41, v41, v41
    v_cvt_pk_bf16_f32 v45, v45, v45
    v_cvt_pk_bf16_f32 v49, v49, v49
    v_cvt_pk_bf16_f32 v53, v53, v53
    v_and_b32 v42, v41, v3
    v_and_b32 v43, v41, v4
    v_and_b32 v46, v45, v3
    v_and_b32 v47, v45, v4
    v_and_b32 v50, v49, v3
    v_and_b32 v51, v49, v4
    v_and_b32 v54, v53, v3
    v_and_b32 v55, v53, v4
    v_mfma_f32_16x16x16_bf16 v[24:27], v[42:43], v[88:89], v[24:27]
    v_mfma_f32_16x16x16_bf16 v[28:31], v[42:43], v[90:91], v[28:31]
    v_mfma_f32_16x16x16_bf16 v[24:27], v[46:47], v[92:93], v[24:27]
    v_mfma_f32_16x16x16_bf16 v[28:31], v[46:47], v[94:95], v[28:31]
    v_mfma_f32_16x16x16_bf16 v[24:27], v[50:51], v[96:97], v[24:27]
    v_mfma_f32_16x16x16_bf16 v[28:31], v[50:51], v[98:99], v[28:31]
    v_mfma_f32_16x16x16_bf16 v[24:27], v[54:55], v[100:101], v[24:27]
    v_mfma_f32_16x16x16_bf16 v[28:31], v[54:55], v[102:103], v[28:31]
    s_bfe_u32 s6, s76, 0x20009
    s_lshl_b32 s6, s6, 2
    s_lshl_b64 s[66:67], s[68:69], s6
    s_add_u32 s76, s76, 32
    v_cndmask_b32 v9, v10, v5, s[66:67]
    v_mov_b32_dpp v40, v14 quad_perm:[0,0,0,0] row_mask:0xf bank_mask:0xf
    v_mov_b32_dpp v44, v14 quad_perm:[1,1,1,1] row_mask:0xf bank_mask:0xf
    v_mov_b32_dpp v48, v14 quad_perm:[2,2,2,2] row_mask:0xf bank_mask:0xf
    v_mov_b32_dpp v52, v14 quad_perm:[3,3,3,3] row_mask:0xf bank_mask:0xf
    v_fma_f32 v41, v40, s65, v9
    v_fma_f32 v45, v44, s65, v9
    v_fma_f32 v49, v48, s65, v9
    v_fma_f32 v53, v52, s65, v9
    v_exp_f32 v41, v41
    v_exp_f32 v45, v45
    v_exp_f32 v49, v49
    v_exp_f32 v53, v53
    v_add_f32 v6, v6, v41
    v_add_f32 v6, v6, v45
    v_add_f32 v6, v6, v49
    v_add_f32 v6, v6, v53
    v_cvt_pk_bf16_f32 v41, v41, v41
    v_cvt_pk_bf16_f32 v45, v45, v45
    v_cvt_pk_bf16_f32 v49, v49, v49
    v_cvt_pk_bf16_f32 v53, v53, v53
    v_and_b32 v42, v41, v3
    v_and_b32 v43, v41, v4
    v_and_b32 v46, v45, v3
    v_and_b32 v47, v45, v4
    v_and_b32 v50, v49, v3
    v_and_b32 v51, v49, v4
    v_and_b32 v54, v53, v3
    v_and_b32 v55, v53, v4
    v_mfma_f32_16x16x16_bf16 v[24:27], v[42:43], v[104:105], v[24:27]
    v_mfma_f32_16x16x16_bf16 v[28:31], v[42:43], v[106:107], v[28:31]
    v_mfma_f32_16x16x16_bf16 v[24:27], v[46:47], v[108:109], v[24:27]
    v_mfma_f32_16x16x16_bf16 v[28:31], v[46:47], v[110:111], v[28:31]
    v_mfma_f32_16x16x16_bf16 v[24:27], v[50:51], v[112:113], v[24:27]
    v_mfma_f32_16x16x16_bf16 v[28:31], v[50:51], v[114:115], v[28:31]
    v_mfma_f32_16x16x16_bf16 v[24:27], v[54:55], v[116:117], v[24:27]
    v_mfma_f32_16x16x16_bf16 v[28:31], v[54:55], v[118:119], v[28:31]
    s_branch L_sdone
L_tail0:
    s_nop 4
    v_mov_b32_dpp v40, v40 quad_perm:[0,0,0,0] row_mask:0xf bank_mask:0xf
    v_mov_b32_dpp v44, v44 quad_perm:[0,0,0,0] row_mask:0xf bank_mask:0xf
    v_mov_b32_dpp v48, v48 quad_perm:[0,0,0,0] row_mask:0xf bank_mask:0xf
    v_mov_b32_dpp v52, v52 quad_perm:[0,0,0,0] row_mask:0xf bank_mask:0xf
    v_add_f32_dpp v40, v41, v40 quad_perm:[1,1,1,1] row_mask:0xf bank_mask:0xf
    v_add_f32_dpp v44, v45, v44 quad_perm:[1,1,1,1] row_mask:0xf bank_mask:0xf
    v_add_f32_dpp v48, v49, v48 quad_perm:[1,1,1,1] row_mask:0xf bank_mask:0xf
    v_add_f32_dpp v52, v53, v52 quad_perm:[1,1,1,1] row_mask:0xf bank_mask:0xf
    v_add_f32_dpp v40, v42, v40 quad_perm:[2,2,2,2] row_mask:0xf bank_mask:0xf
    v_add_f32_dpp v44, v46, v44 quad_perm:[2,2,2,2] row_mask:0xf bank_mask:0xf
    v_add_f32_dpp v48, v50, v48 quad_perm:[2,2,2,2] row_mask:0xf bank_mask:0xf
    v_add_f32_dpp v52, v54, v52 quad_perm:[2,2,2,2] row_mask:0xf bank_mask:0xf
    v_add_f32_dpp v40, v43, v40 quad_perm:[3,3,3,3] row_mask:0xf bank_mask:0xf
    v_add_f32_dpp v44, v47, v44 quad_perm:[3,3,3,3] row_mask:0xf bank_mask:0xf
    v_add_f32_dpp v48, v51, v48 quad_perm:[3,3,3,3] row_mask:0xf bank_mask:0xf
    v_add_f32_dpp v52, v55, v52 quad_perm:[3,3,3,3] row_mask:0xf bank_mask:0xf
    v_fma_f32 v41, v40, s65, v9
    v_fma_f32 v45, v44, s65, v9
    v_fma_f32 v49, v48, s65, v9
    v_fma_f32 v53, v52, s65, v9
    v_max3_f32 v12, v41, v45, v49
    v_max_f32 v12, v12, v53
    v_cmp_lt_f32 vcc, 0, v12
    s_cbranch_vccnz L_resc_17
L_back_18:
    v_exp_f32 v41, v41
    v_exp_f32 v45, v45
    v_exp_f32 v49, v49
    v_exp_f32 v53, v53
    v_add_f32 v6, v6, v41
    v_add_f32 v6, v6, v45
    v_add_f32 v6, v6, v49
    v_add_f32 v6, v6, v53
    v_cvt_pk_bf16_f32 v41, v41, v41
    v_cvt_pk_bf16_f32 v45, v45, v45
    v_cvt_pk_bf16_f32 v49, v49, v49
    v_cvt_pk_bf16_f32 v53, v53, v53
    v_and_b32 v42, v41, v3
    v_and_b32 v43, v41, v4
    v_and_b32 v46, v45, v3
    v_and_b32 v47, v45, v4
    v_and_b32 v50, v49, v3
    v_and_b32 v51, v49, v4
    v_and_b32 v54, v53, v3
    v_and_b32 v55, v53, v4
    v_mfma_f32_16x16x16_bf16 v[24:27], v[42:43], v[136:137], v[24:27]
    v_mfma_f32_16x16x16_bf16 v[28:31], v[42:43], v[138:139], v[28:31]
    v_mfma_f32_16x16x16_bf16 v[24:27], v[46:47], v[140:141], v[24:27]
    v_mfma_f32_16x16x16_bf16 v[28:31], v[46:47], v[142:143], v[28:31]
    v_mfma_f32_16x16x16_bf16 v[24:27], v[50:51], v[144:145], v[24:27]
    v_mfma_f32_16x16x16_bf16 v[28:31], v[50:51], v[146:147], v[28:31]
    v_mfma_f32_16x16x16_bf16 v[24:27], v[54:55], v[148:149], v[24:27]
    v_mfma_f32_16x16x16_bf16 v[28:31], v[54:55], v[150:151], v[28:31]
    s_branch L_sdone
L_tail1:
    s_nop 4
    v_mov_b32_dpp v40, v40 quad_perm:[0,0,0,0] row_mask:0xf bank_mask:0xf
    v_mov_b32_dpp v44, v44 quad_perm:[0,0,0,0] row_mask:0xf bank_mask:0xf
    v_mov_b32_dpp v48, v48 quad_perm:[0,0,0,0] row_mask:0xf bank_mask:0xf
    v_mov_b32_dpp v52, v52 quad_perm:[0,0,0,0] row_mask:0xf bank_mask:0xf
    v_add_f32_dpp v40, v41, v40 quad_perm:[1,1,1,1] row_mask:0xf bank_mask:0xf
    v_add_f32_dpp v44, v45, v44 quad_perm:[1,1,1,1] row_mask:0xf bank_mask:0xf
    v_add_f32_dpp v48, v49, v48 quad_perm:[1,1,1,1] row_mask:0xf bank_mask:0xf
    v_add_f32_dpp v52, v53, v52 quad_perm:[1,1,1,1] row_mask:0xf bank_mask:0xf
    v_add_f32_dpp v40, v42, v40 quad_perm:[2,2,2,2] row_mask:0xf bank_mask:0xf
    v_add_f32_dpp v44, v46, v44 quad_perm:[2,2,2,2] row_mask:0xf bank_mask:0xf
    v_add_f32_dpp v48, v50, v48 quad_perm:[2,2,2,2] row_mask:0xf bank_mask:0xf
    v_add_f32_dpp v52, v54, v52 quad_perm:[2,2,2,2] row_mask:0xf bank_mask:0xf
    v_add_f32_dpp v40, v43, v40 quad_perm:[3,3,3,3] row_mask:0xf bank_mask:0xf
    v_add_f32_dpp v44, v47, v44 quad_perm:[3,3,3,3] row_mask:0xf bank_mask:0xf
    v_add_f32_dpp v48, v51, v48 quad_perm:[3,3,3,3] row_mask:0xf bank_mask:0xf
    v_add_f32_dpp v52, v55, v52 quad_perm:[3,3,3,3] row_mask:0xf bank_mask:0xf
    v_fma_f32 v41, v40, s65, v9
    v_fma_f32 v45, v44, s65, v9
    v_fma_f32 v49, v48, s65, v9
    v_fma_f32 v53, v52, s65, v9
    v_max3_f32 v12, v41, v45, v49
    v_max_f32 v12, v12, v53
    v_cmp_lt_f32 vcc, 0, v12
    s_cbranch_vccnz L_resc_19
L_back_20:
    v_exp_f32 v41, v41
    v_exp_f32 v45, v45
    v_exp_f32 v49, v49
    v_exp_f32 v53, v53
    v_add_f32 v6, v6, v41
    v_add_f32 v6, v6, v45
    v_add_f32 v6, v6, v49
    v_add_f32 v6, v6, v53
    v_cvt_pk_bf16_f32 v41, v41, v41
    v_cvt_pk_bf16_f32 v45, v45, v45
    v_cvt_pk_bf16_f32 v49, v49, v49
    v_cvt_pk_bf16_f32 v53, v53, v53
    v_and_b32 v42, v41, v3
    v_and_b32 v43, v41, v4
    v_and_b32 v46, v45, v3
    v_and_b32 v47, v45, v4
    v_and_b32 v50, v49, v3
    v_and_b32 v51, v49, v4
    v_and_b32 v54, v53, v3
    v_and_b32 v55, v53, v4
    v_mfma_f32_16x16x16_bf16 v[24:27], v[42:43], v[168:169], v[24:27]
    v_mfma_f32_16x16x16_bf16 v[28:31], v[42:43], v[170:171], v[28:31]
    v_mfma_f32_16x16x16_bf16 v[24:27], v[46:47], v[172:173], v[24:27]
    v_mfma_f32_16x16x16_bf16 v[28:31], v[46:47], v[174:175], v[28:31]
    v_mfma_f32_16x16x16_bf16 v[24:27], v[50:51], v[176:177], v[24:27]
    v_mfma_f32_16x16x16_bf16 v[28:31], v[50:51], v[178:179], v[28:31]
    v_mfma_f32_16x16x16_bf16 v[24:27], v[54:55], v[180:181], v[24:27]
    v_mfma_f32_16x16x16_bf16 v[28:31], v[54:55], v[182:183], v[28:31]
    s_branch L_sdone
L_resc_5:
    v_max3_f32 v12, v40, v44, v48
    v_max_f32 v12, v12, v52
    v_mul_f32 v12, s65, v12
    v_mov_b32 v13, v12
    s_nop 1
    v_permlane16_swap_b32 v12, v13
    s_nop 1
    v_max_f32 v12, v12, v13
    v_mov_b32 v13, v12
    s_nop 1
    v_permlane32_swap_b32 v12, v13
    s_nop 1
    v_max_f32 v12, v12, v13
    v_min_f32 v13, v7, -v12
    v_sub_f32 v14, v13, v7
    v_exp_f32 v14, v14
    v_mov_b32 v7, v13
    v_mul_f32 v8, v8, v14
    ds_bpermute_b32 v12, v11, v14
    v_fma_f32 v41, v40, s65, v7
    v_fma_f32 v45, v44, s65, v7
    v_fma_f32 v49, v48, s65, v7
    v_fma_f32 v53, v52, s65, v7
    s_waitcnt lgkmcnt(0)
    v_mul_f32 v32, v32, v12
    v_mul_f32 v33, v33, v12
    v_mul_f32 v34, v34, v12
    v_mul_f32 v35, v35, v12
    v_mul_f32 v36, v36, v12
    v_mul_f32 v37, v37, v12
    v_mul_f32 v38, v38, v12
    v_mul_f32 v39, v39, v12
    s_branch L_back_6
L_resc_7:
    v_max3_f32 v12, v40, v44, v48
    v_max_f32 v12, v12, v52
    v_mul_f32 v12, s65, v12
    v_mov_b32 v13, v12
    s_nop 1
    v_permlane16_swap_b32 v12, v13
    s_nop 1
    v_max_f32 v12, v12, v13
    v_mov_b32 v13, v12
    s_nop 1
    v_permlane32_swap_b32 v12, v13
    s_nop 1
    v_max_f32 v12, v12, v13
    v_min_f32 v13, v7, -v12
    v_sub_f32 v14, v13, v7
    v_exp_f32 v14, v14
    v_mov_b32 v7, v13
    v_mul_f32 v8, v8, v14
    ds_bpermute_b32 v12, v11, v14
    v_fma_f32 v41, v40, s65, v7
    v_fma_f32 v45, v44, s65, v7
    v_fma_f32 v49, v48, s65, v7
    v_fma_f32 v53, v52, s65, v7
    s_waitcnt lgkmcnt(0)
    v_mul_f32 v32, v32, v12
    v_mul_f32 v33, v33, v12
    v_mul_f32 v34, v34, v12
    v_mul_f32 v35, v35, v12
    v_mul_f32 v36, v36, v12
    v_mul_f32 v37, v37, v12
    v_mul_f32 v38, v38, v12
    v_mul_f32 v39, v39, v12
    s_branch L_back_8
L_resc_9:
    v_max3_f32 v12, v40, v44, v48
    v_max_f32 v12, v12, v52
    v_mul_f32 v12, s65, v12
    v_mov_b32 v13, v12
    s_nop 1
    v_permlane16_swap_b32 v12, v13
    s_nop 1
    v_max_f32 v12, v12, v13
    v_mov_b32 v13, v12
    s_nop 1
    v_permlane32_swap_b32 v12, v13
    s_nop 1
    v_max_f32 v12, v12, v13
    v_min_f32 v13, v7, -v12
    v_sub_f32 v14, v13, v7
    v_exp_f32 v14, v14
    v_mov_b32 v7, v13
    v_mul_f32 v8, v8, v14
    ds_bpermute_b32 v12, v11, v14
    v_fma_f32 v41, v40, s65, v7
    v_fma_f32 v45, v44, s65, v7
    v_fma_f32 v49, v48, s65, v7
    v_fma_f32 v53, v52, s65, v7
    s_waitcnt lgkmcnt(0)
    v_mul_f32 v32, v32, v12
    v_mul_f32 v33, v33, v12
    v_mul_f32 v34, v34, v12
    v_mul_f32 v35, v35, v12
    v_mul_f32 v36, v36, v12
    v_mul_f32 v37, v37, v12
    v_mul_f32 v38, v38, v12
    v_mul_f32 v39, v39, v12
    s_branch L_back_10
L_resc_11:
    v_max3_f32 v12, v40, v44, v48
    v_max_f32 v12, v12, v52
    v_mul_f32 v12, s65, v12
    v_mov_b32 v13, v12
    s_nop 1
    v_permlane16_swap_b32 v12, v13
    s_nop 1
    v_max_f32 v12, v12, v13
    v_mov_b32 v13, v12
    s_nop 1
    v_permlane32_swap_b32 v12, v13
    s_nop 1
    v_max_f32 v12, v12, v13
    v_min_f32 v13, v7, -v12
    v_sub_f32 v14, v13, v7
    v_exp_f32 v14, v14
    v_mov_b32 v7, v13
    v_mul_f32 v8, v8, v14
    ds_bpermute_b32 v12, v11, v14
    v_fma_f32 v41, v40, s65, v7
    v_fma_f32 v45, v44, s65, v7
    v_fma_f32 v49, v48, s65, v7
    v_fma_f32 v53, v52, s65, v7
    s_waitcnt lgkmcnt(0)
    v_mul_f32 v32, v32, v12
    v_mul_f32 v33, v33, v12
    v_mul_f32 v34, v34, v12
    v_mul_f32 v35, v35, v12
    v_mul_f32 v36, v36, v12
    v_mul_f32 v37, v37, v12
    v_mul_f32 v38, v38, v12
    v_mul_f32 v39, v39, v12
    s_branch L_back_12
L_resc_13:
    v_max3_f32 v12, v40, v44, v48
    v_max_f32 v12, v12, v52
    v_mul_f32 v12, s65, v12
    v_cndmask_b32 v12, v10, v12, s[66:67]
    v_mov_b32 v13, v12
    s_nop 1
    v_permlane16_swap_b32 v12, v13
    s_nop 1
    v_max_f32 v12, v12, v13
    v_mov_b32 v13, v12
    s_nop 1
    v_permlane32_swap_b32 v12, v13
    s_nop 1
    v_max_f32 v12, v12, v13
    v_min_f32 v13, v5, -v12
    v_sub_f32 v14, v13, v5
    v_exp_f32 v14, v14
    v_mov_b32 v5, v13
    v_mul_f32 v6, v6, v14
    ds_bpermute_b32 v12, v11, v14
    v_cndmask_b32 v9, v10, v5, s[66:67]
    v_fma_f32 v41, v40, s65, v9
    v_fma_f32 v45, v44, s65, v9
    v_fma_f32 v49, v48, s65, v9
    v_fma_f32 v53, v52, s65, v9
    s_waitcnt lgkmcnt(0)
    v_mul_f32 v24, v24, v12
    v_mul_f32 v25, v25, v12
    v_mul_f32 v26, v26, v12
    v_mul_f32 v27, v27, v12
    v_mul_f32 v28, v28, v12
    v_mul_f32 v29, v29, v12
    v_mul_f32 v30, v30, v12
    v_mul_f32 v31, v31, v12
    s_branch L_back_14
L_resc_15:
    v_max3_f32 v12, v40, v44, v48
    v_max_f32 v12, v12, v52
    v_mul_f32 v12, s65, v12
    v_cndmask_b32 v12, v10, v12, s[66:67]
    v_mov_b32 v13, v12
    s_nop 1
    v_permlane16_swap_b32 v12, v13
    s_nop 1
    v_max_f32 v12, v12, v13
    v_mov_b32 v13, v12
    s_nop 1
    v_permlane32_swap_b32 v12, v13
    s_nop 1
    v_max_f32 v12, v12, v13
    v_min_f32 v13, v5, -v12
    v_sub_f32 v14, v13, v5
    v_exp_f32 v14, v14
    v_mov_b32 v5, v13
    v_mul_f32 v6, v6, v14
    ds_bpermute_b32 v12, v11, v14
    v_cndmask_b32 v9, v10, v5, s[66:67]
    v_fma_f32 v41, v40, s65, v9
    v_fma_f32 v45, v44, s65, v9
    v_fma_f32 v49, v48, s65, v9
    v_fma_f32 v53, v52, s65, v9
    s_waitcnt lgkmcnt(0)
    v_mul_f32 v24, v24, v12
    v_mul_f32 v25, v25, v12
    v_mul_f32 v26, v26, v12
    v_mul_f32 v27, v27, v12
    v_mul_f32 v28, v28, v12
    v_mul_f32 v29, v29, v12
    v_mul_f32 v30, v30, v12
    v_mul_f32 v31, v31, v12
    s_branch L_back_16
L_resc_17:
    v_max3_f32 v12, v40, v44, v48
    v_max_f32 v12, v12, v52
    v_mul_f32 v12, s65, v12
    v_cndmask_b32 v12, v10, v12, s[66:67]
    v_mov_b32 v13, v12
    s_nop 1
    v_permlane16_swap_b32 v12, v13
    s_nop 1
    v_max_f32 v12, v12, v13
    v_mov_b32 v13, v12
    s_nop 1
    v_permlane32_swap_b32 v12, v13
    s_nop 1
    v_max_f32 v12, v12, v13
    v_min_f32 v13, v5, -v12
    v_sub_f32 v14, v13, v5
    v_exp_f32 v14, v14
    v_mov_b32 v5, v13
    v_mul_f32 v6, v6, v14
    ds_bpermute_b32 v12, v11, v14
    v_cndmask_b32 v9, v10, v5, s[66:67]
    v_fma_f32 v41, v40, s65, v9
    v_fma_f32 v45, v44, s65, v9
    v_fma_f32 v49, v48, s65, v9
    v_fma_f32 v53, v52, s65, v9
    s_waitcnt lgkmcnt(0)
    v_mul_f32 v24, v24, v12
    v_mul_f32 v25, v25, v12
    v_mul_f32 v26, v26, v12
    v_mul_f32 v27, v27, v12
    v_mul_f32 v28, v28, v12
    v_mul_f32 v29, v29, v12
    v_mul_f32 v30, v30, v12
    v_mul_f32 v31, v31, v12
    s_branch L_back_18
L_resc_19:
    v_max3_f32 v12, v40, v44, v48
    v_max_f32 v12, v12, v52
    v_mul_f32 v12, s65, v12
    v_cndmask_b32 v12, v10, v12, s[66:67]
    v_mov_b32 v13, v12
    s_nop 1
    v_permlane16_swap_b32 v12, v13
    s_nop 1
    v_max_f32 v12, v12, v13
    v_mov_b32 v13, v12
    s_nop 1
    v_permlane32_swap_b32 v12, v13
    s_nop 1
    v_max_f32 v12, v12, v13
    v_min_f32 v13, v5, -v12
    v_sub_f32 v14, v13, v5
    v_exp_f32 v14, v14
    v_mov_b32 v5, v13
    v_mul_f32 v6, v6, v14
    ds_bpermute_b32 v12, v11, v14
    v_cndmask_b32 v9, v10, v5, s[66:67]
    v_fma_f32 v41, v40, s65, v9
    v_fma_f32 v45, v44, s65, v9
    v_fma_f32 v49, v48, s65, v9
    v_fma_f32 v53, v52, s65, v9
    s_waitcnt lgkmcnt(0)
    v_mul_f32 v24, v24, v12
    v_mul_f32 v25, v25, v12
    v_mul_f32 v26, v26, v12
    v_mul_f32 v27, v27, v12
    v_mul_f32 v28, v28, v12
    v_mul_f32 v29, v29, v12
    v_mul_f32 v30, v30, v12
    v_mul_f32 v31, v31, v12
    s_branch L_back_20
L_sdone:
    v_mov_b32 v13, v6
    s_nop 1
    v_permlane16_swap_b32 v6, v13
    s_nop 1
    v_add_f32 v6, v6, v13
    v_mov_b32 v13, v6
    s_nop 1
    v_permlane32_swap_b32 v6, v13
    s_nop 1
    v_add_f32 v6, v6, v13
    s_lshl_b32 s6, s3, 11
    v_add_u32 v12, s6, v2
    s_lshl_b32 s6, s3, 5
    v_and_b32 v13, 12, v0
    v_lshl_add_u32 v13, v13, 1, s6
    ds_write_b128 v12, v[24:27] offset:0
    ds_write_b128 v12, v[28:31] offset:1024
    v_add_u32 v13, 2240, v13
    ds_write2_b32 v13, v5, v6 offset0:0 offset1:1
    s_waitcnt lgkmcnt(0)
    s_barrier
    s_endpgm
L_helperB:
    s_setprio 2
    v_mov_b32 v160, 0
    v_mov_b32 v161, 0
    v_mov_b32 v162, 0
    v_mov_b32 v163, 0
    v_mov_b32 v9, 2048
    ds_write_b128 v9, v[160:163]
    ds_write_b128 v9, v[160:163] offset:16
    v_lshrrev_b32 v6, 4, v0
    v_and_b32 v7, 15, v0
    v_bfe_u32 v8, v0, 2, 2
    s_lshl_b32 s6, s5, 7
    v_lshl_add_u32 v2, v8, 10, s6
    v_lshl_add_u32 v2, v6, 5, v2
    s_lshl_b32 s6, s5, 19
    s_lshl_b32 s7, s4, 8
    s_add_u32 s6, s6, s7
    v_lshl_add_u32 v3, v6, 17, s6
    v_lshl_add_u32 v3, v7, 4, v3
    s_waitcnt lgkmcnt(0)
    s_mov_b32 s6, 0x180600
    s_load_dword s68, s[40:41], s6
    s_mul_i32 s7, s4, 14336
    s_add_u32 s7, s7, 0x180400
    s_mov_b32 s71, 0
    s_atomic_add s71, s[40:41], s7 glc
    s_mov_b32 s48, s26
    s_mov_b32 s49, s27
    s_mov_b32 s50, 0x1000
    s_mov_b32 s51, 0x20000
    s_mov_b32 s44, s32
    s_mov_b32 s45, s33
    s_mov_b32 s46, 0x400000
    s_mov_b32 s47, 0x20000
    buffer_load_dwordx4 v[24:27], v2, s[48:51], 0 offen
    buffer_load_dwordx4 v[28:31], v2, s[48:51], 0 offen offset:16
    s_mov_b32 s6, 0
    buffer_load_dwordx4 v[44:47], v3, s[44:47], s6 offen nt
    s_add_u32 s6, s6, 8192
    buffer_load_dwordx4 v[48:51], v3, s[44:47], s6 offen nt
    s_add_u32 s6, s6, 8192
    buffer_load_dwordx4 v[52:55], v3, s[44:47], s6 offen nt
    s_add_u32 s6, s6, 8192
    buffer_load_dwordx4 v[56:59], v3, s[44:47], s6 offen nt
    s_add_u32 s6, s6, 8192
    buffer_load_dwordx4 v[60:63], v3, s[44:47], s6 offen nt
    s_add_u32 s6, s6, 8192
    buffer_load_dwordx4 v[64:67], v3, s[44:47], s6 offen nt
    s_add_u32 s6, s6, 8192
    buffer_load_dwordx4 v[68:71], v3, s[44:47], s6 offen nt
    s_add_u32 s6, s6, 8192
    buffer_load_dwordx4 v[72:75], v3, s[44:47], s6 offen nt
    s_add_u32 s6, s6, 8192
    buffer_load_dwordx4 v[76:79], v3, s[44:47], s6 offen nt
    s_add_u32 s6, s6, 8192
    buffer_load_dwordx4 v[80:83], v3, s[44:47], s6 offen nt
    s_add_u32 s6, s6, 8192
    buffer_load_dwordx4 v[84:87], v3, s[44:47], s6 offen nt
    s_add_u32 s6, s6, 8192
    buffer_load_dwordx4 v[88:91], v3, s[44:47], s6 offen nt
    s_add_u32 s6, s6, 8192
    buffer_load_dwordx4 v[92:95], v3, s[44:47], s6 offen nt
    s_add_u32 s6, s6, 8192
    buffer_load_dwordx4 v[96:99], v3, s[44:47], s6 offen nt
    s_add_u32 s6, s6, 8192
    buffer_load_dwordx4 v[100:103], v3, s[44:47], s6 offen nt
    s_add_u32 s6, s6, 8192
    buffer_load_dwordx4 v[104:107], v3, s[44:47], s6 offen nt
    s_mov_b32 s52, s40
    s_mov_b32 s53, s41
    s_mov_b32 s54, 0x500000
    s_mov_b32 s55, 0x20000
    s_mov_b32 s64, s36
    s_mov_b32 s65, s37
    s_mov_b32 s66, 0x2000
    s_mov_b32 s67, 0x20000
    s_barrier
    v_lshlrev_b32 v1, 4, v0
    s_lshl_b32 s69, s2, 11
    s_add_u32 s70, s69, 0x180000
    v_lshlrev_b32 v11, 3, v6
    v_mov_b32 v10, 0xff
    v_and_b32 v4, 1, v0
    v_lshlrev_b32 v4, 4, v4
    v_mov_b32 v9, 0xffff
    v_lshlrev_b32 v9, v4, v9
    v_and_b32 v5, 2, v0
    v_cmp_eq_u32 vcc, 0, v5
    s_nop 1
    v_cndmask_b32 v4, 0, v9, vcc
    v_cndmask_b32 v5, v9, 0, vcc
    s_lshl_b32 s8, s4, 14
    s_and_b32 s9, s4, 28
    s_lshl_b32 s9, s9, 14
    s_and_b32 s7, s4, 3
    v_lshrrev_b32 v9, 1, v7
    v_lshlrev_b32 v9, 11, v9
    v_and_b32 v40, 1, v0
    v_lshl_add_u32 v17, v40, 4, v9
    v_lshl_add_u32 v17, v6, 5, v17
    v_add_u32 v17, s8, v17
    s_lshl_b32 s6, s5, 8
    v_add_u32 v16, s6, v17
    v_lshl_add_u32 v19, v40, 5, v9
    v_lshl_add_u32 v19, v6, 6, v19
    s_add_u32 s6, s8, 0x180000
    v_add_u32 v19, s6, v19
    v_lshlrev_b32 v18, 4, v6
    v_bfe_u32 v9, v0, 1, 2
    v_lshlrev_b32 v21, 11, v6
    v_lshl_add_u32 v21, v9, 4, v21
    v_lshlrev_b32 v22, 6, v9
    v_lshl_add_u32 v22, v40, 5, v22
    v_and_b32 v9, 8, v0
    v_lshl_add_u32 v22, v9, 1, v22
    v_lshl_add_u32 v22, v6, 8, v22
    v_lshlrev_b32 v12, 10, v6
    v_lshl_add_u32 v12, v8, 7, v12
    v_and_b32 v9, 3, v0
    v_lshl_add_u32 v12, v9, 3, v12
    v_lshlrev_b32 v13, 8, v9
    v_lshl_add_u32 v13, v6, 4, v13
    v_lshlrev_b32 v14, 14, v9
    v_lshrrev_b32 v9, 5, v0
    v_lshl_add_u32 v14, v9, 16, v14
    v_and_b32 v8, 1, v6
    v_lshl_add_u32 v14, v8, 4, v14
    v_and_b32 v15, 31, v0
    v_lshlrev_b32 v15, 6, v15
    v_lshl_add_u32 v15, v9, 4, v15
    s_waitcnt lgkmcnt(0)
    s_add_u32 s68, s68, 1
    v_mov_b32 v162, s71
    v_mov_b32 v9, 2048
    ds_write_b32 v9, v162 offset:8
    s_mov_b32 s8, 0x01000100
    s_mov_b32 s9, 0x03020302
    s_waitcnt vmcnt(12)
    v_perm_b32 v6, v24, v24, s8
    v_and_b32 v40, v6, v4
    v_and_b32 v41, v6, v5
    s_nop 1
    v_mfma_f32_16x16x16_bf16 v[32:35], v[40:41], v[44:45], 0
    v_mfma_f32_16x16x16_bf16 v[36:39], v[40:41], v[46:47], 0
    v_perm_b32 v6, v24, v24, s9
    v_and_b32 v42, v6, v4
    v_and_b32 v43, v6, v5
    s_nop 1
    v_mfma_f32_16x16x16_bf16 v[32:35], v[42:43], v[48:49], v[32:35]
    v_mfma_f32_16x16x16_bf16 v[36:39], v[42:43], v[50:51], v[36:39]
    v_perm_b32 v6, v25, v25, s8
    v_and_b32 v40, v6, v4
    v_and_b32 v41, v6, v5
    s_nop 1
    v_mfma_f32_16x16x16_bf16 v[32:35], v[40:41], v[52:53], v[32:35]
    v_mfma_f32_16x16x16_bf16 v[36:39], v[40:41], v[54:55], v[36:39]
    v_perm_b32 v6, v25, v25, s9
    v_and_b32 v42, v6, v4
    v_and_b32 v43, v6, v5
    s_nop 1
    v_mfma_f32_16x16x16_bf16 v[32:35], v[42:43], v[56:57], v[32:35]
    v_mfma_f32_16x16x16_bf16 v[36:39], v[42:43], v[58:59], v[36:39]
    s_waitcnt vmcnt(8)
    v_perm_b32 v6, v26, v26, s8
    v_and_b32 v40, v6, v4
    v_and_b32 v41, v6, v5
    s_nop 1
    v_mfma_f32_16x16x16_bf16 v[32:35], v[40:41], v[60:61], v[32:35]
    v_mfma_f32_16x16x16_bf16 v[36:39], v[40:41], v[62:63], v[36:39]
    v_perm_b32 v6, v26, v26, s9
    v_and_b32 v42, v6, v4
    v_and_b32 v43, v6, v5
    s_nop 1
    v_mfma_f32_16x16x16_bf16 v[32:35], v[42:43], v[64:65], v[32:35]
    v_mfma_f32_16x16x16_bf16 v[36:39], v[42:43], v[66:67], v[36:39]
    v_perm_b32 v6, v27, v27, s8
    v_and_b32 v40, v6, v4
    v_and_b32 v41, v6, v5
    s_nop 1
    v_mfma_f32_16x16x16_bf16 v[32:35], v[40:41], v[68:69], v[32:35]
    v_mfma_f32_16x16x16_bf16 v[36:39], v[40:41], v[70:71], v[36:39]
    v_perm_b32 v6, v27, v27, s9
    v_and_b32 v42, v6, v4
    v_and_b32 v43, v6, v5
    s_nop 1
    v_mfma_f32_16x16x16_bf16 v[32:35], v[42:43], v[72:73], v[32:35]
    v_mfma_f32_16x16x16_bf16 v[36:39], v[42:43], v[74:75], v[36:39]
    s_waitcnt vmcnt(4)
    v_perm_b32 v6, v28, v28, s8
    v_and_b32 v40, v6, v4
    v_and_b32 v41, v6, v5
    s_nop 1
    v_mfma_f32_16x16x16_bf16 v[32:35], v[40:41], v[76:77], v[32:35]
    v_mfma_f32_16x16x16_bf16 v[36:39], v[40:41], v[78:79], v[36:39]
    v_perm_b32 v6, v28, v28, s9
    v_and_b32 v42, v6, v4
    v_and_b32 v43, v6, v5
    s_nop 1
    v_mfma_f32_16x16x16_bf16 v[32:35], v[42:43], v[80:81], v[32:35]
    v_mfma_f32_16x16x16_bf16 v[36:39], v[42:43], v[82:83], v[36:39]
    v_perm_b32 v6, v29, v29, s8
    v_and_b32 v40, v6, v4
    v_and_b32 v41, v6, v5
    s_nop 1
    v_mfma_f32_16x16x16_bf16 v[32:35], v[40:41], v[84:85], v[32:35]
    v_mfma_f32_16x16x16_bf16 v[36:39], v[40:41], v[86:87], v[36:39]
    v_perm_b32 v6, v29, v29, s9
    v_and_b32 v42, v6, v4
    v_and_b32 v43, v6, v5
    s_nop 1
    v_mfma_f32_16x16x16_bf16 v[32:35], v[42:43], v[88:89], v[32:35]
    v_mfma_f32_16x16x16_bf16 v[36:39], v[42:43], v[90:91], v[36:39]
    s_waitcnt vmcnt(0)
    v_perm_b32 v6, v30, v30, s8
    v_and_b32 v40, v6, v4
    v_and_b32 v41, v6, v5
    s_nop 1
    v_mfma_f32_16x16x16_bf16 v[32:35], v[40:41], v[92:93], v[32:35]
    v_mfma_f32_16x16x16_bf16 v[36:39], v[40:41], v[94:95], v[36:39]
    v_perm_b32 v6, v30, v30, s9
    v_and_b32 v42, v6, v4
    v_and_b32 v43, v6, v5
    s_nop 1
    v_mfma_f32_16x16x16_bf16 v[32:35], v[42:43], v[96:97], v[32:35]
    v_mfma_f32_16x16x16_bf16 v[36:39], v[42:43], v[98:99], v[36:39]
    v_perm_b32 v6, v31, v31, s8
    v_and_b32 v40, v6, v4
    v_and_b32 v41, v6, v5
    s_nop 1
    v_mfma_f32_16x16x16_bf16 v[32:35], v[40:41], v[100:101], v[32:35]
    v_mfma_f32_16x16x16_bf16 v[36:39], v[40:41], v[102:103], v[36:39]
    v_perm_b32 v6, v31, v31, s9
    v_and_b32 v42, v6, v4
    v_and_b32 v43, v6, v5
    s_nop 1
    v_mfma_f32_16x16x16_bf16 v[32:35], v[42:43], v[104:105], v[32:35]
    v_mfma_f32_16x16x16_bf16 v[36:39], v[42:43], v[106:107], v[36:39]
    s_nop 7
    v_bfi_b32 v32, v10, s68, v32
    v_bfi_b32 v33, v10, s68, v33
    v_bfi_b32 v34, v10, s68, v34
    v_bfi_b32 v35, v10, s68, v35
    v_bfi_b32 v36, v10, s68, v36
    v_bfi_b32 v37, v10, s68, v37
    v_bfi_b32 v38, v10, s68, v38
    v_bfi_b32 v39, v10, s68, v39
    s_mov_b32 s6, 0x0
    buffer_store_dwordx4 v[32:35], v16, s[52:55], s6 offen sc1
    buffer_store_dwordx4 v[36:39], v16, s[52:55], s6 offen offset:128 sc1
    s_add_u32 s6, s69, 0x0
    s_mov_b32 s7, 131072
L_spin_21:
    buffer_load_dwordx4 v[44:47], v1, s[52:55], s6 offen sc1
    buffer_load_dwordx4 v[48:51], v1, s[52:55], s6 offen offset:1024 sc1
    s_waitcnt vmcnt(0)
    v_xor_b32 v23, s68, v44
    v_bitop3_b32 v23, v23, v45, s68 bitop3:0xf6
    v_bitop3_b32 v23, v23, v46, s68 bitop3:0xf6
    v_bitop3_b32 v23, v23, v47, s68 bitop3:0xf6
    v_bitop3_b32 v23, v23, v48, s68 bitop3:0xf6
    v_bitop3_b32 v23, v23, v49, s68 bitop3:0xf6
    v_bitop3_b32 v23, v23, v50, s68 bitop3:0xf6
    v_bitop3_b32 v23, v23, v51, s68 bitop3:0xf6
    v_and_b32 v23, v23, v10
    v_cmp_ne_u32 vcc, 0, v23
    s_cbranch_vccz L_ok_22
    s_sub_u32 s7, s7, 1
    s_cmp_lg_u32 s7, 0
    s_cbranch_scc1 L_spin_21
L_ok_22:
    v_add_f32 v44, v44, v48
    v_add_f32 v45, v45, v49
    v_add_f32 v46, v46, v50
    v_add_f32 v47, v47, v51
    v_mov_b32 v48, v44
    v_mov_b32 v49, v45
    v_mov_b32 v50, v46
    v_mov_b32 v51, v47
    v_permlane16_swap_b32 v44, v48
    v_permlane16_swap_b32 v45, v49
    v_permlane16_swap_b32 v46, v50
    v_permlane16_swap_b32 v47, v51
    v_add_f32 v44, v44, v48
    v_add_f32 v45, v45, v49
    v_add_f32 v46, v46, v50
    v_add_f32 v47, v47, v51
    v_mov_b32 v48, v44
    v_mov_b32 v49, v45
    v_mov_b32 v50, v46
    v_mov_b32 v51, v47
    v_permlane32_swap_b32 v44, v48
    v_permlane32_swap_b32 v45, v49
    v_permlane32_swap_b32 v46, v50
    v_permlane32_swap_b32 v47, v51
    v_add_f32 v44, v44, v48
    v_add_f32 v45, v45, v49
    v_add_f32 v46, v46, v50
    v_add_f32 v47, v47, v51
    v_bfi_b32 v44, v10, s68, v44
    v_bfi_b32 v45, v10, s68, v45
    v_bfi_b32 v46, v10, s68, v46
    v_bfi_b32 v47, v10, s68, v47
    s_mov_b64 exec, 0xfffff
    buffer_store_dwordx4 v[44:47], v22, s[52:55], s70 offen offset:0 sc1
    s_mov_b64 exec, -1
    s_mov_b32 s7, 131072
L_spin_23:
    buffer_load_dwordx4 v[52:55], v19, s[52:55], 0 offen offset:0 sc1
    buffer_load_dwordx4 v[56:59], v19, s[52:55], 0 offen offset:16 sc1
    s_waitcnt vmcnt(0)
    v_xor_b32 v23, s68, v52
    v_bitop3_b32 v23, v23, v53, s68 bitop3:0xf6
    v_bitop3_b32 v23, v23, v54, s68 bitop3:0xf6
    v_bitop3_b32 v23, v23, v55, s68 bitop3:0xf6
    v_bitop3_b32 v23, v23, v56, s68 bitop3:0xf6
    v_bitop3_b32 v23, v23, v57, s68 bitop3:0xf6
    v_bitop3_b32 v23, v23, v58, s68 bitop3:0xf6
    v_bitop3_b32 v23, v23, v59, s68 bitop3:0xf6
    v_and_b32 v23, v23, v10
    v_cmp_ne_u32 vcc, 0, v23
    s_cbranch_vccz L_ok_24
    s_sub_u32 s7, s7, 1
    s_cmp_lg_u32 s7, 0
    s_cbranch_scc1 L_spin_23
L_ok_24:
    v_cvt_pk_bf16_f32 v40, v52, v53
    v_cvt_pk_bf16_f32 v41, v54, v55
    v_cvt_pk_bf16_f32 v42, v56, v57
    v_cvt_pk_bf16_f32 v43, v58, v59
    ds_write_b128 v1, v[40:43] offset:0
    s_waitcnt lgkmcnt(0)
    v_mov_b32 v9, 2048
    ds_write_b32 v9, v10 offset:12
    s_setprio 0
    s_mov_b32 s7, 524288
    v_mov_b32 v9, 2048
L_wait_25:
    ds_read_b32 v7, v9 offset:16
    s_waitcnt lgkmcnt(0)
    v_readfirstlane_b32 s6, v7
    s_cmp_lg_u32 s6, 0
    s_cbranch_scc1 L_set_26
    s_sleep 8
    s_sub_u32 s7, s7, 1
    s_cmp_lg_u32 s7, 0
    s_cbranch_scc1 L_wait_25
L_set_26:
    ds_read_b64_tr_b16 v[160:161], v12 offset:20480
    ds_read_b64_tr_b16 v[162:163], v12 offset:20992
    ds_read_b64_tr_b16 v[164:165], v12 offset:24576
    ds_read_b64_tr_b16 v[166:167], v12 offset:25088
    s_waitcnt lgkmcnt(0)
    ds_read_b64_tr_b16 v[168:169], v12 offset:28672
    ds_read_b64_tr_b16 v[170:171], v12 offset:29184
    ds_read_b64_tr_b16 v[172:173], v12 offset:32768
    ds_read_b64_tr_b16 v[174:175], v12 offset:33280
    s_waitcnt lgkmcnt(0)
    ds_read_b64_tr_b16 v[176:177], v12 offset:20512
    ds_read_b64_tr_b16 v[178:179], v12 offset:21024
    ds_read_b64_tr_b16 v[180:181], v12 offset:24608
    ds_read_b64_tr_b16 v[182:183], v12 offset:25120
    s_waitcnt lgkmcnt(0)
    ds_read_b64_tr_b16 v[184:185], v12 offset:28704
    ds_read_b64_tr_b16 v[186:187], v12 offset:29216
    ds_read_b64_tr_b16 v[188:189], v12 offset:32800
    ds_read_b64_tr_b16 v[190:191], v12 offset:33312
    s_waitcnt lgkmcnt(0)
    ds_read_b64_tr_b16 v[192:193], v12 offset:20544
    ds_read_b64_tr_b16 v[194:195], v12 offset:21056
    ds_read_b64_tr_b16 v[196:197], v12 offset:24640
    ds_read_b64_tr_b16 v[198:199], v12 offset:25152
    s_waitcnt lgkmcnt(0)
    ds_read_b64_tr_b16 v[200:201], v12 offset:28736
    ds_read_b64_tr_b16 v[202:203], v12 offset:29248
    ds_read_b64_tr_b16 v[204:205], v12 offset:32832
    ds_read_b64_tr_b16 v[206:207], v12 offset:33344
    s_waitcnt lgkmcnt(0)
    ds_read_b64_tr_b16 v[208:209], v12 offset:20576
    ds_read_b64_tr_b16 v[210:211], v12 offset:21088
    ds_read_b64_tr_b16 v[212:213], v12 offset:24672
    ds_read_b64_tr_b16 v[214:215], v12 offset:25184
    s_waitcnt lgkmcnt(0)
    ds_read_b64_tr_b16 v[216:217], v12 offset:28768
    ds_read_b64_tr_b16 v[218:219], v12 offset:29280
    ds_read_b64_tr_b16 v[220:221], v12 offset:32864
    ds_read_b64_tr_b16 v[222:223], v12 offset:33376
    s_waitcnt lgkmcnt(0)
    s_add_u32 s68, s68, 0x80
    s_and_b32 s6, s4, 3
    s_lshl_b32 s6, s6, 11
    s_lshr_b32 s9, s4, 2
    s_lshl_b32 s9, s9, 4
    s_add_u32 s6, s6, s9
    s_lshl_b32 s9, s5, 7
    s_add_u32 s6, s6, s9
    v_lshrrev_b32 v2, 5, v0
    v_lshl_add_u32 v2, v2, 3, s6
    s_setprio 2
    s_barrier
    ds_read_b64 v[108:109], v11 offset:2304
    ds_read_b64 v[110:111], v11 offset:2336
    ds_read_b64 v[112:113], v11 offset:2368
    ds_read_b64 v[114:115], v11 offset:2400
    ds_read_b128 v[44:47], v1 offset:4096
    ds_read_b128 v[48:51], v1 offset:5120
    ds_read_b128 v[52:55], v1 offset:6144
    ds_read_b128 v[56:59], v1 offset:7168
    ds_read_b128 v[60:63], v1 offset:8192
    ds_read_b128 v[64:67], v1 offset:9216
    ds_read_b128 v[68:71], v1 offset:10240
    ds_read_b128 v[72:75], v1 offset:11264
    s_waitcnt lgkmcnt(8)
    v_min3_f32 v6, v108, v110, v112
    v_min_f32 v6, v6, v114
    v_sub_f32 v108, v6, v108
    v_sub_f32 v110, v6, v110
    v_sub_f32 v112, v6, v112
    v_sub_f32 v114, v6, v114
    v_exp_f32 v108, v108
    v_exp_f32 v110, v110
    v_exp_f32 v112, v112
    v_exp_f32 v114, v114
    v_mov_b32 v8, s68
    v_mov_b32 v9, s68
    v_mul_f32 v7, v108, v109
    v_fmac_f32 v7, v110, v111
    v_fmac_f32 v7, v112, v113
    v_fmac_f32 v7, v114, v115
    s_waitcnt lgkmcnt(6)
    v_mul_f32 v32, v44, v108
    v_mul_f32 v33, v45, v108
    v_mul_f32 v34, v46, v108
    v_mul_f32 v35, v47, v108
    v_mul_f32 v36, v48, v108
    v_mul_f32 v37, v49, v108
    v_mul_f32 v38, v50, v108
    v_mul_f32 v39, v51, v108
    s_waitcnt lgkmcnt(4)
    v_fmac_f32 v32, v52, v110
    v_fmac_f32 v33, v53, v110
    v_fmac_f32 v34, v54, v110
    v_fmac_f32 v35, v55, v110
    v_fmac_f32 v36, v56, v110
    v_fmac_f32 v37, v57, v110
    v_fmac_f32 v38, v58, v110
    v_fmac_f32 v39, v59, v110
    s_waitcnt lgkmcnt(2)
    v_fmac_f32 v32, v60, v112
    v_fmac_f32 v33, v61, v112
    v_fmac_f32 v34, v62, v112
    v_fmac_f32 v35, v63, v112
    v_fmac_f32 v36, v64, v112
    v_fmac_f32 v37, v65, v112
    v_fmac_f32 v38, v66, v112
    v_fmac_f32 v39, v67, v112
    s_waitcnt lgkmcnt(0)
    v_fmac_f32 v32, v68, v114
    v_fmac_f32 v33, v69, v114
    v_fmac_f32 v34, v70, v114
    v_fmac_f32 v35, v71, v114
    v_fmac_f32 v36, v72, v114
    v_fmac_f32 v37, v73, v114
    v_fmac_f32 v38, v74, v114
    v_fmac_f32 v39, v75, v114
    s_mov_b32 exec_lo, 0x00010001
    s_mov_b32 exec_hi, 0x00010001
    buffer_store_dwordx4 v[6:9], v18, s[52:55], s70 offen offset:256 sc1
    s_mov_b64 exec, -1
    v_bfi_b32 v32, v10, s68, v32
    v_bfi_b32 v33, v10, s68, v33
    v_bfi_b32 v34, v10, s68, v34
    v_bfi_b32 v35, v10, s68, v35
    v_bfi_b32 v36, v10, s68, v36
    v_bfi_b32 v37, v10, s68, v37
    v_bfi_b32 v38, v10, s68, v38
    v_bfi_b32 v39, v10, s68, v39
    s_mov_b32 s6, 0x0
    buffer_store_dwordx4 v[32:35], v16, s[52:55], s6 offen sc1
    buffer_store_dwordx4 v[36:39], v16, s[52:55], s6 offen offset:128 sc1
    s_lshl_b32 s8, s4, 14
    s_add_u32 s8, s8, 0x180000
    s_add_u32 s6, s8, 0
    buffer_load_dwordx4 v[108:111], v18, s[52:55], s6 offen offset:256 sc1
    buffer_load_dwordx4 v[44:47], v17, s[52:55], 0 offen offset:0 sc1
    buffer_load_dwordx4 v[48:51], v17, s[52:55], 0 offen offset:128 sc1
    s_add_u32 s6, s8, 2048
    buffer_load_dwordx4 v[112:115], v18, s[52:55], s6 offen offset:256 sc1
    buffer_load_dwordx4 v[52:55], v17, s[52:55], 0 offen offset:256 sc1
    buffer_load_dwordx4 v[56:59], v17, s[52:55], 0 offen offset:384 sc1
    s_add_u32 s6, s8, 4096
    buffer_load_dwordx4 v[116:119], v18, s[52:55], s6 offen offset:256 sc1
    buffer_load_dwordx4 v[60:63], v17, s[52:55], 0 offen offset:512 sc1
    buffer_load_dwordx4 v[64:67], v17, s[52:55], 0 offen offset:640 sc1
    s_add_u32 s6, s8, 6144
    buffer_load_dwordx4 v[120:123], v18, s[52:55], s6 offen offset:256 sc1
    buffer_load_dwordx4 v[68:71], v17, s[52:55], 0 offen offset:768 sc1
    buffer_load_dwordx4 v[72:75], v17, s[52:55], 0 offen offset:896 sc1
    s_add_u32 s6, s8, 8192
    buffer_load_dwordx4 v[124:127], v18, s[52:55], s6 offen offset:256 sc1
    buffer_load_dwordx4 v[76:79], v17, s[52:55], 0 offen offset:1024 sc1
    buffer_load_dwordx4 v[80:83], v17, s[52:55], 0 offen offset:1152 sc1
    s_add_u32 s6, s8, 10240
    buffer_load_dwordx4 v[128:131], v18, s[52:55], s6 offen offset:256 sc1
    buffer_load_dwordx4 v[84:87], v17, s[52:55], 0 offen offset:1280 sc1
    buffer_load_dwordx4 v[88:91], v17, s[52:55], 0 offen offset:1408 sc1
    s_add_u32 s6, s8, 12288
    buffer_load_dwordx4 v[132:135], v18, s[52:55], s6 offen offset:256 sc1
    buffer_load_dwordx4 v[92:95], v17, s[52:55], 0 offen offset:1536 sc1
    buffer_load_dwordx4 v[96:99], v17, s[52:55], 0 offen offset:1664 sc1
    s_add_u32 s6, s8, 14336
    buffer_load_dwordx4 v[136:139], v18, s[52:55], s6 offen offset:256 sc1
    buffer_load_dwordx4 v[100:103], v17, s[52:55], 0 offen offset:1792 sc1
    buffer_load_dwordx4 v[104:107], v17, s[52:55], 0 offen offset:1920 sc1
    s_mov_b32 s9, 0
    s_waitcnt vmcnt(21)
    v_xor_b32 v23, s68, v44
    v_bitop3_b32 v23, v23, v45, s68 bitop3:0xf6
    v_bitop3_b32 v23, v23, v46, s68 bitop3:0xf6
    v_bitop3_b32 v23, v23, v47, s68 bitop3:0xf6
    v_bitop3_b32 v23, v23, v48, s68 bitop3:0xf6
    v_bitop3_b32 v23, v23, v49, s68 bitop3:0xf6
    v_bitop3_b32 v23, v23, v50, s68 bitop3:0xf6
    v_bitop3_b32 v23, v23, v51, s68 bitop3:0xf6
    v_and_b32 v23, v23, v10
    v_bitop3_b32 v23, v23, v110, s68 bitop3:0xf6
    v_bitop3_b32 v23, v23, v111, s68 bitop3:0xf6
    v_cmp_ne_u32 vcc, 0, v23
    s_cmp_lg_u64 vcc, 0
    s_cselect_b32 s6, 1, 0
    s_or_b32 s9, s9, s6
    s_waitcnt vmcnt(18)
    v_xor_b32 v23, s68, v52
    v_bitop3_b32 v23, v23, v53, s68 bitop3:0xf6
    v_bitop3_b32 v23, v23, v54, s68 bitop3:0xf6
    v_bitop3_b32 v23, v23, v55, s68 bitop3:0xf6
    v_bitop3_b32 v23, v23, v56, s68 bitop3:0xf6
    v_bitop3_b32 v23, v23, v57, s68 bitop3:0xf6
    v_bitop3_b32 v23, v23, v58, s68 bitop3:0xf6
    v_bitop3_b32 v23, v23, v59, s68 bitop3:0xf6
    v_and_b32 v23, v23, v10
    v_bitop3_b32 v23, v23, v114, s68 bitop3:0xf6
    v_bitop3_b32 v23, v23, v115, s68 bitop3:0xf6
    v_cmp_ne_u32 vcc, 0, v23
    s_cmp_lg_u64 vcc, 0
    s_cselect_b32 s6, 2, 0
    s_or_b32 s9, s9, s6
    s_waitcnt vmcnt(15)
    v_xor_b32 v23, s68, v60
    v_bitop3_b32 v23, v23, v61, s68 bitop3:0xf6
    v_bitop3_b32 v23, v23, v62, s68 bitop3:0xf6
    v_bitop3_b32 v23, v23, v63, s68 bitop3:0xf6
    v_bitop3_b32 v23, v23, v64, s68 bitop3:0xf6
    v_bitop3_b32 v23, v23, v65, s68 bitop3:0xf6
    v_bitop3_b32 v23, v23, v66, s68 bitop3:0xf6
    v_bitop3_b32 v23, v23, v67, s68 bitop3:0xf6
    v_and_b32 v23, v23, v10
    v_bitop3_b32 v23, v23, v118, s68 bitop3:0xf6
    v_bitop3_b32 v23, v23, v119, s68 bitop3:0xf6
    v_cmp_ne_u32 vcc, 0, v23
    s_cmp_lg_u64 vcc, 0
    s_cselect_b32 s6, 4, 0
    s_or_b32 s9, s9, s6
    s_waitcnt vmcnt(12)
    v_xor_b32 v23, s68, v68
    v_bitop3_b32 v23, v23, v69, s68 bitop3:0xf6
    v_bitop3_b32 v23, v23, v70, s68 bitop3:0xf6
    v_bitop3_b32 v23, v23, v71, s68 bitop3:0xf6
    v_bitop3_b32 v23, v23, v72, s68 bitop3:0xf6
    v_bitop3_b32 v23, v23, v73, s68 bitop3:0xf6
    v_bitop3_b32 v23, v23, v74, s68 bitop3:0xf6
    v_bitop3_b32 v23, v23, v75, s68 bitop3:0xf6
    v_and_b32 v23, v23, v10
    v_bitop3_b32 v23, v23, v122, s68 bitop3:0xf6
    v_bitop3_b32 v23, v23, v123, s68 bitop3:0xf6
    v_cmp_ne_u32 vcc, 0, v23
    s_cmp_lg_u64 vcc, 0
    s_cselect_b32 s6, 8, 0
    s_or_b32 s9, s9, s6
    s_waitcnt vmcnt(9)
    v_xor_b32 v23, s68, v76
    v_bitop3_b32 v23, v23, v77, s68 bitop3:0xf6
    v_bitop3_b32 v23, v23, v78, s68 bitop3:0xf6
    v_bitop3_b32 v23, v23, v79, s68 bitop3:0xf6
    v_bitop3_b32 v23, v23, v80, s68 bitop3:0xf6
    v_bitop3_b32 v23, v23, v81, s68 bitop3:0xf6
    v_bitop3_b32 v23, v23, v82, s68 bitop3:0xf6
    v_bitop3_b32 v23, v23, v83, s68 bitop3:0xf6
    v_and_b32 v23, v23, v10
    v_bitop3_b32 v23, v23, v126, s68 bitop3:0xf6
    v_bitop3_b32 v23, v23, v127, s68 bitop3:0xf6
    v_cmp_ne_u32 vcc, 0, v23
    s_cmp_lg_u64 vcc, 0
    s_cselect_b32 s6, 16, 0
    s_or_b32 s9, s9, s6
    s_waitcnt vmcnt(6)
    v_xor_b32 v23, s68, v84
    v_bitop3_b32 v23, v23, v85, s68 bitop3:0xf6
    v_bitop3_b32 v23, v23, v86, s68 bitop3:0xf6
    v_bitop3_b32 v23, v23, v87, s68 bitop3:0xf6
    v_bitop3_b32 v23, v23, v88, s68 bitop3:0xf6
    v_bitop3_b32 v23, v23, v89, s68 bitop3:0xf6
    v_bitop3_b32 v23, v23, v90, s68 bitop3:0xf6
    v_bitop3_b32 v23, v23, v91, s68 bitop3:0xf6
    v_and_b32 v23, v23, v10
    v_bitop3_b32 v23, v23, v130, s68 bitop3:0xf6
    v_bitop3_b32 v23, v23, v131, s68 bitop3:0xf6
    v_cmp_ne_u32 vcc, 0, v23
    s_cmp_lg_u64 vcc, 0
    s_cselect_b32 s6, 32, 0
    s_or_b32 s9, s9, s6
    s_waitcnt vmcnt(3)
    v_xor_b32 v23, s68, v92
    v_bitop3_b32 v23, v23, v93, s68 bitop3:0xf6
    v_bitop3_b32 v23, v23, v94, s68 bitop3:0xf6
    v_bitop3_b32 v23, v23, v95, s68 bitop3:0xf6
    v_bitop3_b32 v23, v23, v96, s68 bitop3:0xf6
    v_bitop3_b32 v23, v23, v97, s68 bitop3:0xf6
    v_bitop3_b32 v23, v23, v98, s68 bitop3:0xf6
    v_bitop3_b32 v23, v23, v99, s68 bitop3:0xf6
    v_and_b32 v23, v23, v10
    v_bitop3_b32 v23, v23, v134, s68 bitop3:0xf6
    v_bitop3_b32 v23, v23, v135, s68 bitop3:0xf6
    v_cmp_ne_u32 vcc, 0, v23
    s_cmp_lg_u64 vcc, 0
    s_cselect_b32 s6, 64, 0
    s_or_b32 s9, s9, s6
    s_waitcnt vmcnt(0)
    v_xor_b32 v23, s68, v100
    v_bitop3_b32 v23, v23, v101, s68 bitop3:0xf6
    v_bitop3_b32 v23, v23, v102, s68 bitop3:0xf6
    v_bitop3_b32 v23, v23, v103, s68 bitop3:0xf6
    v_bitop3_b32 v23, v23, v104, s68 bitop3:0xf6
    v_bitop3_b32 v23, v23, v105, s68 bitop3:0xf6
    v_bitop3_b32 v23, v23, v106, s68 bitop3:0xf6
    v_bitop3_b32 v23, v23, v107, s68 bitop3:0xf6
    v_and_b32 v23, v23, v10
    v_bitop3_b32 v23, v23, v138, s68 bitop3:0xf6
    v_bitop3_b32 v23, v23, v139, s68 bitop3:0xf6
    v_cmp_ne_u32 vcc, 0, v23
    s_cmp_lg_u64 vcc, 0
    s_cselect_b32 s6, 128, 0
    s_or_b32 s9, s9, s6
    s_cbranch_scc0 L_ok_27
    s_mov_b32 s7, 131072
L_spin_28:
    s_bitcmp1_b32 s9, 0
    s_cbranch_scc0 L_sk_29
    s_add_u32 s6, s8, 0
    buffer_load_dwordx4 v[108:111], v18, s[52:55], s6 offen offset:256 sc1
    buffer_load_dwordx4 v[44:47], v17, s[52:55], 0 offen offset:0 sc1
    buffer_load_dwordx4 v[48:51], v17, s[52:55], 0 offen offset:128 sc1
L_sk_29:
    s_bitcmp1_b32 s9, 1
    s_cbranch_scc0 L_sk_30
    s_add_u32 s6, s8, 2048
    buffer_load_dwordx4 v[112:115], v18, s[52:55], s6 offen offset:256 sc1
    buffer_load_dwordx4 v[52:55], v17, s[52:55], 0 offen offset:256 sc1
    buffer_load_dwordx4 v[56:59], v17, s[52:55], 0 offen offset:384 sc1
L_sk_30:
    s_bitcmp1_b32 s9, 2
    s_cbranch_scc0 L_sk_31
    s_add_u32 s6, s8, 4096
    buffer_load_dwordx4 v[116:119], v18, s[52:55], s6 offen offset:256 sc1
    buffer_load_dwordx4 v[60:63], v17, s[52:55], 0 offen offset:512 sc1
    buffer_load_dwordx4 v[64:67], v17, s[52:55], 0 offen offset:640 sc1
L_sk_31:
    s_bitcmp1_b32 s9, 3
    s_cbranch_scc0 L_sk_32
    s_add_u32 s6, s8, 6144
    buffer_load_dwordx4 v[120:123], v18, s[52:55], s6 offen offset:256 sc1
    buffer_load_dwordx4 v[68:71], v17, s[52:55], 0 offen offset:768 sc1
    buffer_load_dwordx4 v[72:75], v17, s[52:55], 0 offen offset:896 sc1
L_sk_32:
    s_bitcmp1_b32 s9, 4
    s_cbranch_scc0 L_sk_33
    s_add_u32 s6, s8, 8192
    buffer_load_dwordx4 v[124:127], v18, s[52:55], s6 offen offset:256 sc1
    buffer_load_dwordx4 v[76:79], v17, s[52:55], 0 offen offset:1024 sc1
    buffer_load_dwordx4 v[80:83], v17, s[52:55], 0 offen offset:1152 sc1
L_sk_33:
    s_bitcmp1_b32 s9, 5
    s_cbranch_scc0 L_sk_34
    s_add_u32 s6, s8, 10240
    buffer_load_dwordx4 v[128:131], v18, s[52:55], s6 offen offset:256 sc1
    buffer_load_dwordx4 v[84:87], v17, s[52:55], 0 offen offset:1280 sc1
    buffer_load_dwordx4 v[88:91], v17, s[52:55], 0 offen offset:1408 sc1
L_sk_34:
    s_bitcmp1_b32 s9, 6
    s_cbranch_scc0 L_sk_35
    s_add_u32 s6, s8, 12288
    buffer_load_dwordx4 v[132:135], v18, s[52:55], s6 offen offset:256 sc1
    buffer_load_dwordx4 v[92:95], v17, s[52:55], 0 offen offset:1536 sc1
    buffer_load_dwordx4 v[96:99], v17, s[52:55], 0 offen offset:1664 sc1
L_sk_35:
    s_bitcmp1_b32 s9, 7
    s_cbranch_scc0 L_sk_36
    s_add_u32 s6, s8, 14336
    buffer_load_dwordx4 v[136:139], v18, s[52:55], s6 offen offset:256 sc1
    buffer_load_dwordx4 v[100:103], v17, s[52:55], 0 offen offset:1792 sc1
    buffer_load_dwordx4 v[104:107], v17, s[52:55], 0 offen offset:1920 sc1
L_sk_36:
    s_waitcnt vmcnt(0)
    s_bitcmp1_b32 s9, 0
    s_cbranch_scc0 L_sk_37
    v_xor_b32 v23, s68, v44
    v_bitop3_b32 v23, v23, v45, s68 bitop3:0xf6
    v_bitop3_b32 v23, v23, v46, s68 bitop3:0xf6
    v_bitop3_b32 v23, v23, v47, s68 bitop3:0xf6
    v_bitop3_b32 v23, v23, v48, s68 bitop3:0xf6
    v_bitop3_b32 v23, v23, v49, s68 bitop3:0xf6
    v_bitop3_b32 v23, v23, v50, s68 bitop3:0xf6
    v_bitop3_b32 v23, v23, v51, s68 bitop3:0xf6
    v_and_b32 v23, v23, v10
    v_bitop3_b32 v23, v23, v110, s68 bitop3:0xf6
    v_bitop3_b32 v23, v23, v111, s68 bitop3:0xf6
    v_cmp_ne_u32 vcc, 0, v23
    s_cbranch_vccnz L_sk_37
    s_bitset0_b32 s9, 0
L_sk_37:
    s_bitcmp1_b32 s9, 1
    s_cbranch_scc0 L_sk_38
    v_xor_b32 v23, s68, v52
    v_bitop3_b32 v23, v23, v53, s68 bitop3:0xf6
    v_bitop3_b32 v23, v23, v54, s68 bitop3:0xf6
    v_bitop3_b32 v23, v23, v55, s68 bitop3:0xf6
    v_bitop3_b32 v23, v23, v56, s68 bitop3:0xf6
    v_bitop3_b32 v23, v23, v57, s68 bitop3:0xf6
    v_bitop3_b32 v23, v23, v58, s68 bitop3:0xf6
    v_bitop3_b32 v23, v23, v59, s68 bitop3:0xf6
    v_and_b32 v23, v23, v10
    v_bitop3_b32 v23, v23, v114, s68 bitop3:0xf6
    v_bitop3_b32 v23, v23, v115, s68 bitop3:0xf6
    v_cmp_ne_u32 vcc, 0, v23
    s_cbranch_vccnz L_sk_38
    s_bitset0_b32 s9, 1
L_sk_38:
    s_bitcmp1_b32 s9, 2
    s_cbranch_scc0 L_sk_39
    v_xor_b32 v23, s68, v60
    v_bitop3_b32 v23, v23, v61, s68 bitop3:0xf6
    v_bitop3_b32 v23, v23, v62, s68 bitop3:0xf6
    v_bitop3_b32 v23, v23, v63, s68 bitop3:0xf6
    v_bitop3_b32 v23, v23, v64, s68 bitop3:0xf6
    v_bitop3_b32 v23, v23, v65, s68 bitop3:0xf6
    v_bitop3_b32 v23, v23, v66, s68 bitop3:0xf6
    v_bitop3_b32 v23, v23, v67, s68 bitop3:0xf6
    v_and_b32 v23, v23, v10
    v_bitop3_b32 v23, v23, v118, s68 bitop3:0xf6
    v_bitop3_b32 v23, v23, v119, s68 bitop3:0xf6
    v_cmp_ne_u32 vcc, 0, v23
    s_cbranch_vccnz L_sk_39
    s_bitset0_b32 s9, 2
L_sk_39:
    s_bitcmp1_b32 s9, 3
    s_cbranch_scc0 L_sk_40
    v_xor_b32 v23, s68, v68
    v_bitop3_b32 v23, v23, v69, s68 bitop3:0xf6
    v_bitop3_b32 v23, v23, v70, s68 bitop3:0xf6
    v_bitop3_b32 v23, v23, v71, s68 bitop3:0xf6
    v_bitop3_b32 v23, v23, v72, s68 bitop3:0xf6
    v_bitop3_b32 v23, v23, v73, s68 bitop3:0xf6
    v_bitop3_b32 v23, v23, v74, s68 bitop3:0xf6
    v_bitop3_b32 v23, v23, v75, s68 bitop3:0xf6
    v_and_b32 v23, v23, v10
    v_bitop3_b32 v23, v23, v122, s68 bitop3:0xf6
    v_bitop3_b32 v23, v23, v123, s68 bitop3:0xf6
    v_cmp_ne_u32 vcc, 0, v23
    s_cbranch_vccnz L_sk_40
    s_bitset0_b32 s9, 3
L_sk_40:
    s_bitcmp1_b32 s9, 4
    s_cbranch_scc0 L_sk_41
    v_xor_b32 v23, s68, v76
    v_bitop3_b32 v23, v23, v77, s68 bitop3:0xf6
    v_bitop3_b32 v23, v23, v78, s68 bitop3:0xf6
    v_bitop3_b32 v23, v23, v79, s68 bitop3:0xf6
    v_bitop3_b32 v23, v23, v80, s68 bitop3:0xf6
    v_bitop3_b32 v23, v23, v81, s68 bitop3:0xf6
    v_bitop3_b32 v23, v23, v82, s68 bitop3:0xf6
    v_bitop3_b32 v23, v23, v83, s68 bitop3:0xf6
    v_and_b32 v23, v23, v10
    v_bitop3_b32 v23, v23, v126, s68 bitop3:0xf6
    v_bitop3_b32 v23, v23, v127, s68 bitop3:0xf6
    v_cmp_ne_u32 vcc, 0, v23
    s_cbranch_vccnz L_sk_41
    s_bitset0_b32 s9, 4
L_sk_41:
    s_bitcmp1_b32 s9, 5
    s_cbranch_scc0 L_sk_42
    v_xor_b32 v23, s68, v84
    v_bitop3_b32 v23, v23, v85, s68 bitop3:0xf6
    v_bitop3_b32 v23, v23, v86, s68 bitop3:0xf6
    v_bitop3_b32 v23, v23, v87, s68 bitop3:0xf6
    v_bitop3_b32 v23, v23, v88, s68 bitop3:0xf6
    v_bitop3_b32 v23, v23, v89, s68 bitop3:0xf6
    v_bitop3_b32 v23, v23, v90, s68 bitop3:0xf6
    v_bitop3_b32 v23, v23, v91, s68 bitop3:0xf6
    v_and_b32 v23, v23, v10
    v_bitop3_b32 v23, v23, v130, s68 bitop3:0xf6
    v_bitop3_b32 v23, v23, v131, s68 bitop3:0xf6
    v_cmp_ne_u32 vcc, 0, v23
    s_cbranch_vccnz L_sk_42
    s_bitset0_b32 s9, 5
L_sk_42:
    s_bitcmp1_b32 s9, 6
    s_cbranch_scc0 L_sk_43
    v_xor_b32 v23, s68, v92
    v_bitop3_b32 v23, v23, v93, s68 bitop3:0xf6
    v_bitop3_b32 v23, v23, v94, s68 bitop3:0xf6
    v_bitop3_b32 v23, v23, v95, s68 bitop3:0xf6
    v_bitop3_b32 v23, v23, v96, s68 bitop3:0xf6
    v_bitop3_b32 v23, v23, v97, s68 bitop3:0xf6
    v_bitop3_b32 v23, v23, v98, s68 bitop3:0xf6
    v_bitop3_b32 v23, v23, v99, s68 bitop3:0xf6
    v_and_b32 v23, v23, v10
    v_bitop3_b32 v23, v23, v134, s68 bitop3:0xf6
    v_bitop3_b32 v23, v23, v135, s68 bitop3:0xf6
    v_cmp_ne_u32 vcc, 0, v23
    s_cbranch_vccnz L_sk_43
    s_bitset0_b32 s9, 6
L_sk_43:
    s_bitcmp1_b32 s9, 7
    s_cbranch_scc0 L_sk_44
    v_xor_b32 v23, s68, v100
    v_bitop3_b32 v23, v23, v101, s68 bitop3:0xf6
    v_bitop3_b32 v23, v23, v102, s68 bitop3:0xf6
    v_bitop3_b32 v23, v23, v103, s68 bitop3:0xf6
    v_bitop3_b32 v23, v23, v104, s68 bitop3:0xf6
    v_bitop3_b32 v23, v23, v105, s68 bitop3:0xf6
    v_bitop3_b32 v23, v23, v106, s68 bitop3:0xf6
    v_bitop3_b32 v23, v23, v107, s68 bitop3:0xf6
    v_and_b32 v23, v23, v10
    v_bitop3_b32 v23, v23, v138, s68 bitop3:0xf6
    v_bitop3_b32 v23, v23, v139, s68 bitop3:0xf6
    v_cmp_ne_u32 vcc, 0, v23
    s_cbranch_vccnz L_sk_44
    s_bitset0_b32 s9, 7
L_sk_44:
    s_cmp_eq_u32 s9, 0
    s_cbranch_scc1 L_ok_27
    s_sub_u32 s7, s7, 1
    s_cmp_lg_u32 s7, 0
    s_cbranch_scc1 L_spin_28
L_ok_27:
    v_min3_f32 v6, v108, v112, v116
    v_min3_f32 v7, v120, v124, v128
    v_min3_f32 v6, v6, v132, v136
    v_min_f32 v6, v6, v7
    v_sub_f32 v108, v6, v108
    v_sub_f32 v112, v6, v112
    v_sub_f32 v116, v6, v116
    v_sub_f32 v120, v6, v120
    v_sub_f32 v124, v6, v124
    v_sub_f32 v128, v6, v128
    v_sub_f32 v132, v6, v132
    v_sub_f32 v136, v6, v136
    v_exp_f32 v108, v108
    v_exp_f32 v112, v112
    v_exp_f32 v116, v116
    v_exp_f32 v120, v120
    v_exp_f32 v124, v124
    v_exp_f32 v128, v128
    v_exp_f32 v132, v132
    v_exp_f32 v136, v136
    v_mul_f32 v7, v108, v109
    v_fmac_f32 v7, v112, v113
    v_fmac_f32 v7, v116, v117
    v_fmac_f32 v7, v120, v121
    v_fmac_f32 v7, v124, v125
    v_fmac_f32 v7, v128, v129
    v_fmac_f32 v7, v132, v133
    v_fmac_f32 v7, v136, v137
    v_rcp_f32 v7, v7
    v_pk_mul_f32 v[32:33], v[44:45], v[108:109] op_sel_hi:[1,0]
    v_pk_mul_f32 v[34:35], v[46:47], v[108:109] op_sel_hi:[1,0]
    v_pk_mul_f32 v[36:37], v[48:49], v[108:109] op_sel_hi:[1,0]
    v_pk_mul_f32 v[38:39], v[50:51], v[108:109] op_sel_hi:[1,0]
    v_pk_fma_f32 v[32:33], v[52:53], v[112:113], v[32:33] op_sel_hi:[1,0,1]
    v_pk_fma_f32 v[34:35], v[54:55], v[112:113], v[34:35] op_sel_hi:[1,0,1]
    v_pk_fma_f32 v[36:37], v[56:57], v[112:113], v[36:37] op_sel_hi:[1,0,1]
    v_pk_fma_f32 v[38:39], v[58:59], v[112:113], v[38:39] op_sel_hi:[1,0,1]
    v_pk_fma_f32 v[32:33], v[60:61], v[116:117], v[32:33] op_sel_hi:[1,0,1]
    v_pk_fma_f32 v[34:35], v[62:63], v[116:117], v[34:35] op_sel_hi:[1,0,1]
    v_pk_fma_f32 v[36:37], v[64:65], v[116:117], v[36:37] op_sel_hi:[1,0,1]
    v_pk_fma_f32 v[38:39], v[66:67], v[116:117], v[38:39] op_sel_hi:[1,0,1]
    v_pk_fma_f32 v[32:33], v[68:69], v[120:121], v[32:33] op_sel_hi:[1,0,1]
    v_pk_fma_f32 v[34:35], v[70:71], v[120:121], v[34:35] op_sel_hi:[1,0,1]
    v_pk_fma_f32 v[36:37], v[72:73], v[120:121], v[36:37] op_sel_hi:[1,0,1]
    v_pk_fma_f32 v[38:39], v[74:75], v[120:121], v[38:39] op_sel_hi:[1,0,1]
    v_pk_fma_f32 v[32:33], v[76:77], v[124:125], v[32:33] op_sel_hi:[1,0,1]
    v_pk_fma_f32 v[34:35], v[78:79], v[124:125], v[34:35] op_sel_hi:[1,0,1]
    v_pk_fma_f32 v[36:37], v[80:81], v[124:125], v[36:37] op_sel_hi:[1,0,1]
    v_pk_fma_f32 v[38:39], v[82:83], v[124:125], v[38:39] op_sel_hi:[1,0,1]
    v_pk_fma_f32 v[32:33], v[84:85], v[128:129], v[32:33] op_sel_hi:[1,0,1]
    v_pk_fma_f32 v[34:35], v[86:87], v[128:129], v[34:35] op_sel_hi:[1,0,1]
    v_pk_fma_f32 v[36:37], v[88:89], v[128:129], v[36:37] op_sel_hi:[1,0,1]
    v_pk_fma_f32 v[38:39], v[90:91], v[128:129], v[38:39] op_sel_hi:[1,0,1]
    v_pk_fma_f32 v[32:33], v[92:93], v[132:133], v[32:33] op_sel_hi:[1,0,1]
    v_pk_fma_f32 v[34:35], v[94:95], v[132:133], v[34:35] op_sel_hi:[1,0,1]
    v_pk_fma_f32 v[36:37], v[96:97], v[132:133], v[36:37] op_sel_hi:[1,0,1]
    v_pk_fma_f32 v[38:39], v[98:99], v[132:133], v[38:39] op_sel_hi:[1,0,1]
    v_pk_fma_f32 v[32:33], v[100:101], v[136:137], v[32:33] op_sel_hi:[1,0,1]
    v_pk_fma_f32 v[34:35], v[102:103], v[136:137], v[34:35] op_sel_hi:[1,0,1]
    v_pk_fma_f32 v[36:37], v[104:105], v[136:137], v[36:37] op_sel_hi:[1,0,1]
    v_pk_fma_f32 v[38:39], v[106:107], v[136:137], v[38:39] op_sel_hi:[1,0,1]
    v_mul_f32 v32, v32, v7
    v_mul_f32 v33, v33, v7
    v_mul_f32 v34, v34, v7
    v_mul_f32 v35, v35, v7
    v_mul_f32 v36, v36, v7
    v_mul_f32 v37, v37, v7
    v_mul_f32 v38, v38, v7
    v_mul_f32 v39, v39, v7
    v_cvt_pk_bf16_f32 v40, v32, v33
    v_cvt_pk_bf16_f32 v41, v34, v35
    v_cvt_pk_bf16_f32 v42, v36, v37
    v_cvt_pk_bf16_f32 v43, v38, v39
    ds_write_b128 v1, v[40:43] offset:53248
    s_waitcnt lgkmcnt(0)
    ds_read_b128 v[44:47], v13 offset:53248
    ds_read_b128 v[48:51], v13 offset:53312
    ds_read_b128 v[52:55], v13 offset:53376
    ds_read_b128 v[56:59], v13 offset:53440
    s_waitcnt lgkmcnt(3)
    v_mfma_f32_16x16x32_bf16 v[60:63], v[160:163], v[44:47], 0
    v_mfma_f32_16x16x32_bf16 v[64:67], v[176:179], v[44:47], 0
    v_mfma_f32_16x16x32_bf16 v[68:71], v[192:195], v[44:47], 0
    v_mfma_f32_16x16x32_bf16 v[72:75], v[208:211], v[44:47], 0
    s_waitcnt lgkmcnt(2)
    v_mfma_f32_16x16x32_bf16 v[60:63], v[164:167], v[48:51], v[60:63]
    v_mfma_f32_16x16x32_bf16 v[64:67], v[180:183], v[48:51], v[64:67]
    v_mfma_f32_16x16x32_bf16 v[68:71], v[196:199], v[48:51], v[68:71]
    v_mfma_f32_16x16x32_bf16 v[72:75], v[212:215], v[48:51], v[72:75]
    s_waitcnt lgkmcnt(1)
    v_mfma_f32_16x16x32_bf16 v[60:63], v[168:171], v[52:55], v[60:63]
    v_mfma_f32_16x16x32_bf16 v[64:67], v[184:187], v[52:55], v[64:67]
    v_mfma_f32_16x16x32_bf16 v[68:71], v[200:203], v[52:55], v[68:71]
    v_mfma_f32_16x16x32_bf16 v[72:75], v[216:219], v[52:55], v[72:75]
    s_waitcnt lgkmcnt(0)
    v_mfma_f32_16x16x32_bf16 v[60:63], v[172:175], v[56:59], v[60:63]
    v_mfma_f32_16x16x32_bf16 v[64:67], v[188:191], v[56:59], v[64:67]
    v_mfma_f32_16x16x32_bf16 v[68:71], v[204:207], v[56:59], v[68:71]
    v_mfma_f32_16x16x32_bf16 v[72:75], v[220:223], v[56:59], v[72:75]
    s_lshl_b32 s6, s5, 11
    s_lshl_b32 s9, s4, 6
    s_add_u32 s6, s6, s9
    s_add_u32 s6, s6, 0x100020
    s_mov_b32 exec_lo, 0x000f000f
    s_mov_b32 exec_hi, 0x000f000f
    v_bfi_b32 v60, v10, s68, v60
    v_bfi_b32 v61, v10, s68, v61
    v_bfi_b32 v62, v10, s68, v62
    v_bfi_b32 v63, v10, s68, v63
    buffer_store_dwordx4 v[60:63], v14, s[52:55], s6 offen sc1
    s_add_u32 s6, s6, 131072
    v_bfi_b32 v64, v10, s68, v64
    v_bfi_b32 v65, v10, s68, v65
    v_bfi_b32 v66, v10, s68, v66
    v_bfi_b32 v67, v10, s68, v67
    buffer_store_dwordx4 v[64:67], v14, s[52:55], s6 offen sc1
    s_add_u32 s6, s6, 131072
    v_bfi_b32 v68, v10, s68, v68
    v_bfi_b32 v69, v10, s68, v69
    v_bfi_b32 v70, v10, s68, v70
    v_bfi_b32 v71, v10, s68, v71
    buffer_store_dwordx4 v[68:71], v14, s[52:55], s6 offen sc1
    s_add_u32 s6, s6, 131072
    v_bfi_b32 v72, v10, s68, v72
    v_bfi_b32 v73, v10, s68, v73
    v_bfi_b32 v74, v10, s68, v74
    v_bfi_b32 v75, v10, s68, v75
    buffer_store_dwordx4 v[72:75], v14, s[52:55], s6 offen sc1
    s_mov_b64 exec, -1
    s_lshl_b32 s6, s2, 11
    s_add_u32 s6, s6, 0x100000
    s_mov_b32 s7, 131072
L_spin_45:
    buffer_load_dwordx4 v[44:47], v15, s[52:55], s6 offen offset:32 sc1
    buffer_load_dwordx4 v[48:51], v15, s[52:55], s6 offen sc1
    s_waitcnt vmcnt(0)
    v_xor_b32 v23, s68, v44
    v_bitop3_b32 v23, v23, v45, s68 bitop3:0xf6
    v_bitop3_b32 v23, v23, v46, s68 bitop3:0xf6
    v_bitop3_b32 v23, v23, v47, s68 bitop3:0xf6
    v_bitop3_b32 v23, v23, v48, s68 bitop3:0xf6
    v_bitop3_b32 v23, v23, v49, s68 bitop3:0xf6
    v_bitop3_b32 v23, v23, v50, s68 bitop3:0xf6
    v_bitop3_b32 v23, v23, v51, s68 bitop3:0xf6
    v_and_b32 v23, v23, v10
    v_cmp_ne_u32 vcc, 0, v23
    s_cbranch_vccz L_ok_46
    s_sleep 2
    s_sub_u32 s7, s7, 1
    s_cmp_lg_u32 s7, 0
    s_cbranch_scc1 L_spin_45
L_ok_46:
    v_add_f32_dpp v44, v44, v44 row_shr:1 row_mask:0xf bank_mask:0xf bound_ctrl:1
    v_add_f32_dpp v45, v45, v45 row_shr:1 row_mask:0xf bank_mask:0xf bound_ctrl:1
    v_add_f32_dpp v46, v46, v46 row_shr:1 row_mask:0xf bank_mask:0xf bound_ctrl:1
    v_add_f32_dpp v47, v47, v47 row_shr:1 row_mask:0xf bank_mask:0xf bound_ctrl:1
    v_add_f32_dpp v48, v48, v48 row_shr:1 row_mask:0xf bank_mask:0xf bound_ctrl:1
    v_add_f32_dpp v49, v49, v49 row_shr:1 row_mask:0xf bank_mask:0xf bound_ctrl:1
    v_add_f32_dpp v50, v50, v50 row_shr:1 row_mask:0xf bank_mask:0xf bound_ctrl:1
    v_add_f32_dpp v51, v51, v51 row_shr:1 row_mask:0xf bank_mask:0xf bound_ctrl:1
    v_add_f32_dpp v44, v44, v44 row_shr:2 row_mask:0xf bank_mask:0xf bound_ctrl:1
    v_add_f32_dpp v45, v45, v45 row_shr:2 row_mask:0xf bank_mask:0xf bound_ctrl:1
    v_add_f32_dpp v46, v46, v46 row_shr:2 row_mask:0xf bank_mask:0xf bound_ctrl:1
    v_add_f32_dpp v47, v47, v47 row_shr:2 row_mask:0xf bank_mask:0xf bound_ctrl:1
    v_add_f32_dpp v48, v48, v48 row_shr:2 row_mask:0xf bank_mask:0xf bound_ctrl:1
    v_add_f32_dpp v49, v49, v49 row_shr:2 row_mask:0xf bank_mask:0xf bound_ctrl:1
    v_add_f32_dpp v50, v50, v50 row_shr:2 row_mask:0xf bank_mask:0xf bound_ctrl:1
    v_add_f32_dpp v51, v51, v51 row_shr:2 row_mask:0xf bank_mask:0xf bound_ctrl:1
    v_add_f32_dpp v44, v44, v44 row_shr:4 row_mask:0xf bank_mask:0xf bound_ctrl:1
    v_add_f32_dpp v45, v45, v45 row_shr:4 row_mask:0xf bank_mask:0xf bound_ctrl:1
    v_add_f32_dpp v46, v46, v46 row_shr:4 row_mask:0xf bank_mask:0xf bound_ctrl:1
    v_add_f32_dpp v47, v47, v47 row_shr:4 row_mask:0xf bank_mask:0xf bound_ctrl:1
    v_add_f32_dpp v48, v48, v48 row_shr:4 row_mask:0xf bank_mask:0xf bound_ctrl:1
    v_add_f32_dpp v49, v49, v49 row_shr:4 row_mask:0xf bank_mask:0xf bound_ctrl:1
    v_add_f32_dpp v50, v50, v50 row_shr:4 row_mask:0xf bank_mask:0xf bound_ctrl:1
    v_add_f32_dpp v51, v51, v51 row_shr:4 row_mask:0xf bank_mask:0xf bound_ctrl:1
    v_add_f32_dpp v44, v44, v44 row_shr:8 row_mask:0xf bank_mask:0xf bound_ctrl:1
    v_add_f32_dpp v45, v45, v45 row_shr:8 row_mask:0xf bank_mask:0xf bound_ctrl:1
    v_add_f32_dpp v46, v46, v46 row_shr:8 row_mask:0xf bank_mask:0xf bound_ctrl:1
    v_add_f32_dpp v47, v47, v47 row_shr:8 row_mask:0xf bank_mask:0xf bound_ctrl:1
    v_add_f32_dpp v48, v48, v48 row_shr:8 row_mask:0xf bank_mask:0xf bound_ctrl:1
    v_add_f32_dpp v49, v49, v49 row_shr:8 row_mask:0xf bank_mask:0xf bound_ctrl:1
    v_add_f32_dpp v50, v50, v50 row_shr:8 row_mask:0xf bank_mask:0xf bound_ctrl:1
    v_add_f32_dpp v51, v51, v51 row_shr:8 row_mask:0xf bank_mask:0xf bound_ctrl:1
    v_add_f32_dpp v44, v44, v44 row_bcast:15 row_mask:0xa bank_mask:0xf
    v_add_f32_dpp v45, v45, v45 row_bcast:15 row_mask:0xa bank_mask:0xf
    v_add_f32_dpp v46, v46, v46 row_bcast:15 row_mask:0xa bank_mask:0xf
    v_add_f32_dpp v47, v47, v47 row_bcast:15 row_mask:0xa bank_mask:0xf
    v_add_f32_dpp v48, v48, v48 row_bcast:15 row_mask:0xa bank_mask:0xf
    v_add_f32_dpp v49, v49, v49 row_bcast:15 row_mask:0xa bank_mask:0xf
    v_add_f32_dpp v50, v50, v50 row_bcast:15 row_mask:0xa bank_mask:0xf
    v_add_f32_dpp v51, v51, v51 row_bcast:15 row_mask:0xa bank_mask:0xf
    v_cvt_pk_bf16_f32 v40, v44, v45
    v_cvt_pk_bf16_f32 v41, v46, v47
    v_cvt_pk_bf16_f32 v42, v48, v49
    v_cvt_pk_bf16_f32 v43, v50, v51
    s_mov_b32 exec_lo, 0x80000000
    s_mov_b32 exec_hi, 0x80000000
    buffer_store_dwordx2 v[40:41], v2, s[64:67], 0 offen offset:1024
    buffer_store_dwordx2 v[42:43], v2, s[64:67], 0 offen
    s_mov_b64 exec, -1
    s_cmp_lg_u32 s2, 0
    s_cbranch_scc1 L_no_epoch
    s_mov_b32 s6, 0x180600
    s_sub_u32 s68, s68, 0x80
    v_mov_b32 v6, s68
    v_mov_b32 v7, 0
    s_mov_b64 exec, 1
    buffer_store_dword v6, v7, s[52:55], s6 offen sc1
L_no_epoch:
    s_endpgm
L_helperA:
    v_lshrrev_b32 v6, 4, v0
    v_and_b32 v7, 15, v0
    v_bfe_u32 v8, v0, 2, 2
    s_lshl_b32 s6, s5, 7
    v_lshl_add_u32 v2, v8, 10, s6
    v_lshl_add_u32 v2, v6, 5, v2
    s_lshl_b32 s6, s5, 19
    s_lshl_b32 s7, s4, 8
    s_add_u32 s6, s6, s7
    v_lshl_add_u32 v3, v6, 17, s6
    v_lshl_add_u32 v3, v7, 4, v3
    s_waitcnt lgkmcnt(0)
    s_mov_b32 s6, 0x180600
    s_load_dword s68, s[40:41], s6
    s_mov_b32 s48, s16
    s_mov_b32 s49, s17
    s_mov_b32 s50, 0x1000
    s_mov_b32 s51, 0x20000
    s_mov_b32 s44, s22
    s_mov_b32 s45, s23
    s_mov_b32 s46, 0x400000
    s_mov_b32 s47, 0x20000
    buffer_load_dwordx4 v[24:27], v2, s[48:51], 0 offen
    buffer_load_dwordx4 v[28:31], v2, s[48:51], 0 offen offset:16
    s_mov_b32 s6, 0
    buffer_load_dwordx4 v[44:47], v3, s[44:47], s6 offen nt
    s_add_u32 s6, s6, 8192
    buffer_load_dwordx4 v[48:51], v3, s[44:47], s6 offen nt
    s_add_u32 s6, s6, 8192
    buffer_load_dwordx4 v[52:55], v3, s[44:47], s6 offen nt
    s_add_u32 s6, s6, 8192
    buffer_load_dwordx4 v[56:59], v3, s[44:47], s6 offen nt
    s_add_u32 s6, s6, 8192
    buffer_load_dwordx4 v[60:63], v3, s[44:47], s6 offen nt
    s_add_u32 s6, s6, 8192
    buffer_load_dwordx4 v[64:67], v3, s[44:47], s6 offen nt
    s_add_u32 s6, s6, 8192
    buffer_load_dwordx4 v[68:71], v3, s[44:47], s6 offen nt
    s_add_u32 s6, s6, 8192
    buffer_load_dwordx4 v[72:75], v3, s[44:47], s6 offen nt
    s_add_u32 s6, s6, 8192
    buffer_load_dwordx4 v[76:79], v3, s[44:47], s6 offen nt
    s_add_u32 s6, s6, 8192
    buffer_load_dwordx4 v[80:83], v3, s[44:47], s6 offen nt
    s_add_u32 s6, s6, 8192
    buffer_load_dwordx4 v[84:87], v3, s[44:47], s6 offen nt
    s_add_u32 s6, s6, 8192
    buffer_load_dwordx4 v[88:91], v3, s[44:47], s6 offen nt
    s_add_u32 s6, s6, 8192
    buffer_load_dwordx4 v[92:95], v3, s[44:47], s6 offen nt
    s_add_u32 s6, s6, 8192
    buffer_load_dwordx4 v[96:99], v3, s[44:47], s6 offen nt
    s_add_u32 s6, s6, 8192
    buffer_load_dwordx4 v[100:103], v3, s[44:47], s6 offen nt
    s_add_u32 s6, s6, 8192
    buffer_load_dwordx4 v[104:107], v3, s[44:47], s6 offen nt
    s_mov_b32 s52, s40
    s_mov_b32 s53, s41
    s_mov_b32 s54, 0x500000
    s_mov_b32 s55, 0x20000
    s_mov_b32 s64, s36
    s_mov_b32 s65, s37
    s_mov_b32 s66, 0x2000
    s_mov_b32 s67, 0x20000
    s_barrier
    v_lshlrev_b32 v1, 4, v0
    s_lshl_b32 s69, s2, 11
    s_add_u32 s70, s69, 0x180000
    v_lshlrev_b32 v11, 3, v6
    v_mov_b32 v10, 0xff
    v_and_b32 v4, 1, v0
    v_lshlrev_b32 v4, 4, v4
    v_mov_b32 v9, 0xffff
    v_lshlrev_b32 v9, v4, v9
    v_and_b32 v5, 2, v0
    v_cmp_eq_u32 vcc, 0, v5
    s_nop 1
    v_cndmask_b32 v4, 0, v9, vcc
    v_cndmask_b32 v5, v9, 0, vcc
    s_lshl_b32 s8, s4, 14
    s_and_b32 s9, s4, 28
    s_lshl_b32 s9, s9, 14
    s_and_b32 s7, s4, 3
    v_lshrrev_b32 v9, 1, v7
    v_lshlrev_b32 v9, 11, v9
    v_and_b32 v40, 1, v0
    v_lshl_add_u32 v17, v40, 4, v9
    v_lshl_add_u32 v17, v6, 5, v17
    v_add_u32 v17, s8, v17
    s_lshl_b32 s6, s5, 8
    v_add_u32 v16, s6, v17
    v_lshl_add_u32 v19, v40, 5, v9
    v_lshl_add_u32 v19, v6, 14, v19
    s_lshl_b32 s6, s7, 6
    s_add_u32 s6, s6, s9
    s_add_u32 s6, s6, 0x180000
    v_add_u32 v19, s6, v19
    v_lshlrev_b32 v20, 4, v7
    v_lshl_add_u32 v17, v6, 14, v20
    s_lshl_b32 s6, s7, 9
    s_add_u32 s6, s6, s9
    v_add_u32 v17, s6, v17
    v_lshl_add_u32 v20, v6, 9, v20
    v_add_u32 v20, s8, v20
    v_bfe_u32 v9, v0, 1, 2
    v_lshlrev_b32 v21, 11, v6
    v_lshl_add_u32 v21, v9, 4, v21
    v_lshlrev_b32 v22, 6, v9
    v_lshl_add_u32 v22, v40, 5, v22
    v_and_b32 v9, 8, v0
    v_lshl_add_u32 v22, v9, 1, v22
    v_lshl_add_u32 v22, v6, 8, v22
    v_lshlrev_b32 v12, 10, v6
    v_lshl_add_u32 v12, v8, 7, v12
    v_and_b32 v9, 3, v0
    v_lshl_add_u32 v12, v9, 3, v12
    v_lshlrev_b32 v13, 8, v9
    v_lshl_add_u32 v13, v6, 4, v13
    v_lshlrev_b32 v14, 14, v9
    v_lshrrev_b32 v9, 5, v0
    v_lshl_add_u32 v14, v9, 16, v14
    v_and_b32 v8, 1, v6
    v_lshl_add_u32 v14, v8, 4, v14
    v_and_b32 v15, 31, v0
    v_lshlrev_b32 v15, 6, v15
    v_lshl_add_u32 v15, v9, 4, v15
    s_waitcnt lgkmcnt(0)
    s_add_u32 s68, s68, 1
    v_lshrrev_b32 v6, 3, v0
    v_and_b32 v7, 7, v0
    s_lshl_b32 s6, s4, 17
    s_lshl_b32 s7, s5, 7
    s_add_u32 s6, s6, s7
    v_lshl_add_u32 v3, v6, 10, s6
    v_lshl_add_u32 v3, v7, 4, v3
    s_mov_b32 s60, s24
    s_mov_b32 s61, s25
    s_mov_b32 s62, 0x400000
    s_mov_b32 s63, 0x20000
    s_mov_b32 m0, 36864
    s_mov_b32 s6, 0
    buffer_load_dwordx4 v3, s[60:63], s6 offen nt lds
    s_mov_b32 m0, 37888
    s_mov_b32 s6, 8192
    buffer_load_dwordx4 v3, s[60:63], s6 offen nt lds
    s_mov_b32 m0, 38912
    s_mov_b32 s6, 16384
    buffer_load_dwordx4 v3, s[60:63], s6 offen nt lds
    s_mov_b32 m0, 39936
    s_mov_b32 s6, 24576
    buffer_load_dwordx4 v3, s[60:63], s6 offen nt lds
    s_mov_b32 m0, 40960
    s_mov_b32 s6, 32768
    buffer_load_dwordx4 v3, s[60:63], s6 offen nt lds
    s_mov_b32 m0, 41984
    s_mov_b32 s6, 40960
    buffer_load_dwordx4 v3, s[60:63], s6 offen nt lds
    s_mov_b32 m0, 43008
    s_mov_b32 s6, 49152
    buffer_load_dwordx4 v3, s[60:63], s6 offen nt lds
    s_mov_b32 m0, 44032
    s_mov_b32 s6, 57344
    buffer_load_dwordx4 v3, s[60:63], s6 offen nt lds
    s_mov_b32 m0, 45056
    s_mov_b32 s6, 65536
    buffer_load_dwordx4 v3, s[60:63], s6 offen nt lds
    s_mov_b32 m0, 46080
    s_mov_b32 s6, 73728
    buffer_load_dwordx4 v3, s[60:63], s6 offen nt lds
    s_mov_b32 m0, 47104
    s_mov_b32 s6, 81920
    buffer_load_dwordx4 v3, s[60:63], s6 offen nt lds
    s_mov_b32 m0, 48128
    s_mov_b32 s6, 90112
    buffer_load_dwordx4 v3, s[60:63], s6 offen nt lds
    s_mov_b32 m0, 49152
    s_mov_b32 s6, 98304
    buffer_load_dwordx4 v3, s[60:63], s6 offen nt lds
    s_mov_b32 m0, 50176
    s_mov_b32 s6, 106496
    buffer_load_dwordx4 v3, s[60:63], s6 offen nt lds
    s_mov_b32 m0, 51200
    s_mov_b32 s6, 114688
    buffer_load_dwordx4 v3, s[60:63], s6 offen nt lds
    s_mov_b32 m0, 52224
    s_mov_b32 s6, 122880
    buffer_load_dwordx4 v3, s[60:63], s6 offen nt lds
    s_mov_b32 s60, s34
    s_mov_b32 s61, s35
    s_mov_b32 s62, 0x400000
    s_mov_b32 s63, 0x20000
    s_waitcnt vmcnt(0)
    s_mov_b32 m0, 20480
    s_mov_b32 s6, 0
    buffer_load_dwordx4 v3, s[60:63], s6 offen nt lds
    s_mov_b32 m0, 21504
    s_mov_b32 s6, 8192
    buffer_load_dwordx4 v3, s[60:63], s6 offen nt lds
    s_mov_b32 m0, 22528
    s_mov_b32 s6, 16384
    buffer_load_dwordx4 v3, s[60:63], s6 offen nt lds
    s_mov_b32 m0, 23552
    s_mov_b32 s6, 24576
    buffer_load_dwordx4 v3, s[60:63], s6 offen nt lds
    s_mov_b32 m0, 24576
    s_mov_b32 s6, 32768
    buffer_load_dwordx4 v3, s[60:63], s6 offen nt lds
    s_mov_b32 m0, 25600
    s_mov_b32 s6, 40960
    buffer_load_dwordx4 v3, s[60:63], s6 offen nt lds
    s_mov_b32 m0, 26624
    s_mov_b32 s6, 49152
    buffer_load_dwordx4 v3, s[60:63], s6 offen nt lds
    s_mov_b32 m0, 27648
    s_mov_b32 s6, 57344
    buffer_load_dwordx4 v3, s[60:63], s6 offen nt lds
    s_mov_b32 m0, 28672
    s_mov_b32 s6, 65536
    buffer_load_dwordx4 v3, s[60:63], s6 offen nt lds
    s_mov_b32 m0, 29696
    s_mov_b32 s6, 73728
    buffer_load_dwordx4 v3, s[60:63], s6 offen nt lds
    s_mov_b32 m0, 30720
    s_mov_b32 s6, 81920
    buffer_load_dwordx4 v3, s[60:63], s6 offen nt lds
    s_mov_b32 m0, 31744
    s_mov_b32 s6, 90112
    buffer_load_dwordx4 v3, s[60:63], s6 offen nt lds
    s_mov_b32 m0, 32768
    s_mov_b32 s6, 98304
    buffer_load_dwordx4 v3, s[60:63], s6 offen nt lds
    s_mov_b32 m0, 33792
    s_mov_b32 s6, 106496
    buffer_load_dwordx4 v3, s[60:63], s6 offen nt lds
    s_mov_b32 m0, 34816
    s_mov_b32 s6, 114688
    buffer_load_dwordx4 v3, s[60:63], s6 offen nt lds
    s_mov_b32 m0, 35840
    s_mov_b32 s6, 122880
    buffer_load_dwordx4 v3, s[60:63], s6 offen nt lds
    s_waitcnt vmcnt(0)
    v_mov_b32 v9, 2048
    ds_write_b32 v9, v10 offset:16
    s_mov_b32 s7, 524288
    v_mov_b32 v9, 2048
L_wait_47:
    ds_read_b32 v7, v9 offset:12
    s_waitcnt lgkmcnt(0)
    v_readfirstlane_b32 s6, v7
    s_cmp_lg_u32 s6, 0
    s_cbranch_scc1 L_set_48
    s_sleep 8
    s_sub_u32 s7, s7, 1
    s_cmp_lg_u32 s7, 0
    s_cbranch_scc1 L_wait_47
L_set_48:
    s_mov_b32 s8, 0x01000100
    s_mov_b32 s9, 0x03020302
    v_perm_b32 v6, v24, v24, s8
    v_and_b32 v40, v6, v4
    v_and_b32 v41, v6, v5
    s_nop 1
    v_mfma_f32_16x16x16_bf16 v[32:35], v[40:41], v[44:45], 0
    v_mfma_f32_16x16x16_bf16 v[36:39], v[40:41], v[46:47], 0
    v_perm_b32 v6, v24, v24, s9
    v_and_b32 v42, v6, v4
    v_and_b32 v43, v6, v5
    s_nop 1
    v_mfma_f32_16x16x16_bf16 v[32:35], v[42:43], v[48:49], v[32:35]
    v_mfma_f32_16x16x16_bf16 v[36:39], v[42:43], v[50:51], v[36:39]
    v_perm_b32 v6, v25, v25, s8
    v_and_b32 v40, v6, v4
    v_and_b32 v41, v6, v5
    s_nop 1
    v_mfma_f32_16x16x16_bf16 v[32:35], v[40:41], v[52:53], v[32:35]
    v_mfma_f32_16x16x16_bf16 v[36:39], v[40:41], v[54:55], v[36:39]
    v_perm_b32 v6, v25, v25, s9
    v_and_b32 v42, v6, v4
    v_and_b32 v43, v6, v5
    s_nop 1
    v_mfma_f32_16x16x16_bf16 v[32:35], v[42:43], v[56:57], v[32:35]
    v_mfma_f32_16x16x16_bf16 v[36:39], v[42:43], v[58:59], v[36:39]
    v_perm_b32 v6, v26, v26, s8
    v_and_b32 v40, v6, v4
    v_and_b32 v41, v6, v5
    s_nop 1
    v_mfma_f32_16x16x16_bf16 v[32:35], v[40:41], v[60:61], v[32:35]
    v_mfma_f32_16x16x16_bf16 v[36:39], v[40:41], v[62:63], v[36:39]
    v_perm_b32 v6, v26, v26, s9
    v_and_b32 v42, v6, v4
    v_and_b32 v43, v6, v5
    s_nop 1
    v_mfma_f32_16x16x16_bf16 v[32:35], v[42:43], v[64:65], v[32:35]
    v_mfma_f32_16x16x16_bf16 v[36:39], v[42:43], v[66:67], v[36:39]
    v_perm_b32 v6, v27, v27, s8
    v_and_b32 v40, v6, v4
    v_and_b32 v41, v6, v5
    s_nop 1
    v_mfma_f32_16x16x16_bf16 v[32:35], v[40:41], v[68:69], v[32:35]
    v_mfma_f32_16x16x16_bf16 v[36:39], v[40:41], v[70:71], v[36:39]
    v_perm_b32 v6, v27, v27, s9
    v_and_b32 v42, v6, v4
    v_and_b32 v43, v6, v5
    s_nop 1
    v_mfma_f32_16x16x16_bf16 v[32:35], v[42:43], v[72:73], v[32:35]
    v_mfma_f32_16x16x16_bf16 v[36:39], v[42:43], v[74:75], v[36:39]
    v_perm_b32 v6, v28, v28, s8
    v_and_b32 v40, v6, v4
    v_and_b32 v41, v6, v5
    s_nop 1
    v_mfma_f32_16x16x16_bf16 v[32:35], v[40:41], v[76:77], v[32:35]
    v_mfma_f32_16x16x16_bf16 v[36:39], v[40:41], v[78:79], v[36:39]
    v_perm_b32 v6, v28, v28, s9
    v_and_b32 v42, v6, v4
    v_and_b32 v43, v6, v5
    s_nop 1
    v_mfma_f32_16x16x16_bf16 v[32:35], v[42:43], v[80:81], v[32:35]
    v_mfma_f32_16x16x16_bf16 v[36:39], v[42:43], v[82:83], v[36:39]
    v_perm_b32 v6, v29, v29, s8
    v_and_b32 v40, v6, v4
    v_and_b32 v41, v6, v5
    s_nop 1
    v_mfma_f32_16x16x16_bf16 v[32:35], v[40:41], v[84:85], v[32:35]
    v_mfma_f32_16x16x16_bf16 v[36:39], v[40:41], v[86:87], v[36:39]
    v_perm_b32 v6, v29, v29, s9
    v_and_b32 v42, v6, v4
    v_and_b32 v43, v6, v5
    s_nop 1
    v_mfma_f32_16x16x16_bf16 v[32:35], v[42:43], v[88:89], v[32:35]
    v_mfma_f32_16x16x16_bf16 v[36:39], v[42:43], v[90:91], v[36:39]
    v_perm_b32 v6, v30, v30, s8
    v_and_b32 v40, v6, v4
    v_and_b32 v41, v6, v5
    s_nop 1
    v_mfma_f32_16x16x16_bf16 v[32:35], v[40:41], v[92:93], v[32:35]
    v_mfma_f32_16x16x16_bf16 v[36:39], v[40:41], v[94:95], v[36:39]
    v_perm_b32 v6, v30, v30, s9
    v_and_b32 v42, v6, v4
    v_and_b32 v43, v6, v5
    s_nop 1
    v_mfma_f32_16x16x16_bf16 v[32:35], v[42:43], v[96:97], v[32:35]
    v_mfma_f32_16x16x16_bf16 v[36:39], v[42:43], v[98:99], v[36:39]
    v_perm_b32 v6, v31, v31, s8
    v_and_b32 v40, v6, v4
    v_and_b32 v41, v6, v5
    s_nop 1
    v_mfma_f32_16x16x16_bf16 v[32:35], v[40:41], v[100:101], v[32:35]
    v_mfma_f32_16x16x16_bf16 v[36:39], v[40:41], v[102:103], v[36:39]
    v_perm_b32 v6, v31, v31, s9
    v_and_b32 v42, v6, v4
    v_and_b32 v43, v6, v5
    s_nop 1
    v_mfma_f32_16x16x16_bf16 v[32:35], v[42:43], v[104:105], v[32:35]
    v_mfma_f32_16x16x16_bf16 v[36:39], v[42:43], v[106:107], v[36:39]
    s_nop 7
    v_bfi_b32 v32, v10, s68, v32
    v_bfi_b32 v33, v10, s68, v33
    v_bfi_b32 v34, v10, s68, v34
    v_bfi_b32 v35, v10, s68, v35
    v_bfi_b32 v36, v10, s68, v36
    v_bfi_b32 v37, v10, s68, v37
    v_bfi_b32 v38, v10, s68, v38
    v_bfi_b32 v39, v10, s68, v39
    s_mov_b32 s6, 0x80000
    buffer_store_dwordx4 v[32:35], v16, s[52:55], s6 offen sc1
    buffer_store_dwordx4 v[36:39], v16, s[52:55], s6 offen offset:128 sc1
    s_add_u32 s6, s69, 0x80000
    s_mov_b32 s7, 131072
L_spin_49:
    buffer_load_dwordx4 v[44:47], v1, s[52:55], s6 offen sc1
    buffer_load_dwordx4 v[48:51], v1, s[52:55], s6 offen offset:1024 sc1
    s_waitcnt vmcnt(0)
    v_xor_b32 v23, s68, v44
    v_bitop3_b32 v23, v23, v45, s68 bitop3:0xf6
    v_bitop3_b32 v23, v23, v46, s68 bitop3:0xf6
    v_bitop3_b32 v23, v23, v47, s68 bitop3:0xf6
    v_bitop3_b32 v23, v23, v48, s68 bitop3:0xf6
    v_bitop3_b32 v23, v23, v49, s68 bitop3:0xf6
    v_bitop3_b32 v23, v23, v50, s68 bitop3:0xf6
    v_bitop3_b32 v23, v23, v51, s68 bitop3:0xf6
    v_and_b32 v23, v23, v10
    v_cmp_ne_u32 vcc, 0, v23
    s_cbranch_vccz L_ok_50
    s_sleep 16
    s_sub_u32 s7, s7, 1
    s_cmp_lg_u32 s7, 0
    s_cbranch_scc1 L_spin_49
L_ok_50:
    v_add_f32 v44, v44, v48
    v_add_f32 v45, v45, v49
    v_add_f32 v46, v46, v50
    v_add_f32 v47, v47, v51
    v_mov_b32 v48, v44
    v_mov_b32 v49, v45
    v_mov_b32 v50, v46
    v_mov_b32 v51, v47
    v_permlane16_swap_b32 v44, v48
    v_permlane16_swap_b32 v45, v49
    v_permlane16_swap_b32 v46, v50
    v_permlane16_swap_b32 v47, v51
    v_add_f32 v44, v44, v48
    v_add_f32 v45, v45, v49
    v_add_f32 v46, v46, v50
    v_add_f32 v47, v47, v51
    v_mov_b32 v48, v44
    v_mov_b32 v49, v45
    v_mov_b32 v50, v46
    v_mov_b32 v51, v47
    v_permlane32_swap_b32 v44, v48
    v_permlane32_swap_b32 v45, v49
    v_permlane32_swap_b32 v46, v50
    v_permlane32_swap_b32 v47, v51
    v_add_f32 v44, v44, v48
    v_add_f32 v45, v45, v49
    v_add_f32 v46, v46, v50
    v_add_f32 v47, v47, v51
    v_bfi_b32 v44, v10, s68, v44
    v_bfi_b32 v45, v10, s68, v45
    v_bfi_b32 v46, v10, s68, v46
    v_bfi_b32 v47, v10, s68, v47
    s_mov_b64 exec, 0xffff
    buffer_store_dwordx4 v[44:47], v22, s[52:55], s70 offen offset:512 sc1
    s_mov_b64 exec, -1
    s_and_b32 s6, s4, 7
    s_cmp_lg_u32 s6, s5
    s_cbranch_scc1 L_no_qa
    s_mov_b32 s7, 131072
L_spin_51:
    buffer_load_dwordx4 v[52:55], v19, s[52:55], 0 offen offset:512 sc1
    buffer_load_dwordx4 v[56:59], v19, s[52:55], 0 offen offset:528 sc1
    s_waitcnt vmcnt(0)
    v_xor_b32 v23, s68, v52
    v_bitop3_b32 v23, v23, v53, s68 bitop3:0xf6
    v_bitop3_b32 v23, v23, v54, s68 bitop3:0xf6
    v_bitop3_b32 v23, v23, v55, s68 bitop3:0xf6
    v_bitop3_b32 v23, v23, v56, s68 bitop3:0xf6
    v_bitop3_b32 v23, v23, v57, s68 bitop3:0xf6
    v_bitop3_b32 v23, v23, v58, s68 bitop3:0xf6
    v_bitop3_b32 v23, v23, v59, s68 bitop3:0xf6
    v_and_b32 v23, v23, v10
    v_cmp_ne_u32 vcc, 0, v23
    s_cbranch_vccz L_ok_52
    s_sleep 16
    s_sub_u32 s7, s7, 1
    s_cmp_lg_u32 s7, 0
    s_cbranch_scc1 L_spin_51
L_ok_52:
    v_cvt_pk_bf16_f32 v40, v52, v53
    v_cvt_pk_bf16_f32 v41, v54, v55
    v_cvt_pk_bf16_f32 v42, v56, v57
    v_cvt_pk_bf16_f32 v43, v58, v59
    ds_write_b128 v1, v[40:43] offset:1024
    s_waitcnt lgkmcnt(0)
    v_mov_b32 v9, 2048
    ds_write_b32 v9, v10
L_no_qa:
    s_waitcnt vmcnt(0)
    ds_read_b64_tr_b16 v[160:161], v12 offset:36864
    ds_read_b64_tr_b16 v[162:163], v12 offset:37376
    ds_read_b64_tr_b16 v[164:165], v12 offset:40960
    ds_read_b64_tr_b16 v[166:167], v12 offset:41472
    s_waitcnt lgkmcnt(0)
    ds_read_b64_tr_b16 v[168:169], v12 offset:45056
    ds_read_b64_tr_b16 v[170:171], v12 offset:45568
    ds_read_b64_tr_b16 v[172:173], v12 offset:49152
    ds_read_b64_tr_b16 v[174:175], v12 offset:49664
    s_waitcnt lgkmcnt(0)
    ds_read_b64_tr_b16 v[176:177], v12 offset:36896
    ds_read_b64_tr_b16 v[178:179], v12 offset:37408
    ds_read_b64_tr_b16 v[180:181], v12 offset:40992
    ds_read_b64_tr_b16 v[182:183], v12 offset:41504
    s_waitcnt lgkmcnt(0)
    ds_read_b64_tr_b16 v[184:185], v12 offset:45088
    ds_read_b64_tr_b16 v[186:187], v12 offset:45600
    ds_read_b64_tr_b16 v[188:189], v12 offset:49184
    ds_read_b64_tr_b16 v[190:191], v12 offset:49696
    s_waitcnt lgkmcnt(0)
    ds_read_b64_tr_b16 v[192:193], v12 offset:36928
    ds_read_b64_tr_b16 v[194:195], v12 offset:37440
    ds_read_b64_tr_b16 v[196:197], v12 offset:41024
    ds_read_b64_tr_b16 v[198:199], v12 offset:41536
    s_waitcnt lgkmcnt(0)
    ds_read_b64_tr_b16 v[200:201], v12 offset:45120
    ds_read_b64_tr_b16 v[202:203], v12 offset:45632
    ds_read_b64_tr_b16 v[204:205], v12 offset:49216
    ds_read_b64_tr_b16 v[206:207], v12 offset:49728
    s_waitcnt lgkmcnt(0)
    ds_read_b64_tr_b16 v[208:209], v12 offset:36960
    ds_read_b64_tr_b16 v[210:211], v12 offset:37472
    ds_read_b64_tr_b16 v[212:213], v12 offset:41056
    ds_read_b64_tr_b16 v[214:215], v12 offset:41568
    s_waitcnt lgkmcnt(0)
    ds_read_b64_tr_b16 v[216:217], v12 offset:45152
    ds_read_b64_tr_b16 v[218:219], v12 offset:45664
    ds_read_b64_tr_b16 v[220:221], v12 offset:49248
    ds_read_b64_tr_b16 v[222:223], v12 offset:49760
    s_waitcnt lgkmcnt(0)
    s_add_u32 s68, s68, 0x80
    s_and_b32 s6, s4, 3
    s_lshl_b32 s6, s6, 11
    s_lshr_b32 s9, s4, 2
    s_lshl_b32 s9, s9, 4
    s_add_u32 s6, s6, s9
    s_lshl_b32 s9, s5, 7
    s_add_u32 s6, s6, s9
    v_lshrrev_b32 v2, 5, v0
    v_lshl_add_u32 v2, v2, 3, s6
    s_and_b32 s6, s4, 7
    s_cmp_lg_u32 s6, s5
    s_cbranch_scc1 L_no_oa
    s_mov_b32 s7, 131072
L_spin_53:
    v_mov_b32 v9, 2052
    ds_read_b32 v7, v9
    s_waitcnt lgkmcnt(0)
    v_cmp_gt_u32 vcc, 0x100, v7
    s_cbranch_vccz L_ok_54
    s_sleep 16
    s_sub_u32 s7, s7, 1
    s_cmp_lg_u32 s7, 0
    s_cbranch_scc1 L_spin_53
L_ok_54:
    ds_read_b64 v[108:109], v11 offset:2432
    ds_read_b64 v[110:111], v11 offset:2464
    ds_read_b64 v[112:113], v11 offset:2496
    ds_read_b64 v[114:115], v11 offset:2528
    ds_read_b128 v[44:47], v1 offset:12288
    ds_read_b128 v[48:51], v1 offset:13312
    ds_read_b128 v[52:55], v1 offset:14336
    ds_read_b128 v[56:59], v1 offset:15360
    ds_read_b128 v[60:63], v1 offset:16384
    ds_read_b128 v[64:67], v1 offset:17408
    ds_read_b128 v[68:71], v1 offset:18432
    ds_read_b128 v[72:75], v1 offset:19456
    s_waitcnt lgkmcnt(8)
    v_min3_f32 v6, v108, v110, v112
    v_min_f32 v6, v6, v114
    v_sub_f32 v108, v6, v108
    v_sub_f32 v110, v6, v110
    v_sub_f32 v112, v6, v112
    v_sub_f32 v114, v6, v114
    v_exp_f32 v108, v108
    v_exp_f32 v110, v110
    v_exp_f32 v112, v112
    v_exp_f32 v114, v114
    v_mov_b32 v8, s68
    v_mov_b32 v9, s68
    v_mul_f32 v7, v108, v109
    v_fmac_f32 v7, v110, v111
    v_fmac_f32 v7, v112, v113
    v_fmac_f32 v7, v114, v115
    s_waitcnt lgkmcnt(6)
    v_mul_f32 v32, v44, v108
    v_mul_f32 v33, v45, v108
    v_mul_f32 v34, v46, v108
    v_mul_f32 v35, v47, v108
    v_mul_f32 v36, v48, v108
    v_mul_f32 v37, v49, v108
    v_mul_f32 v38, v50, v108
    v_mul_f32 v39, v51, v108
    s_waitcnt lgkmcnt(4)
    v_fmac_f32 v32, v52, v110
    v_fmac_f32 v33, v53, v110
    v_fmac_f32 v34, v54, v110
    v_fmac_f32 v35, v55, v110
    v_fmac_f32 v36, v56, v110
    v_fmac_f32 v37, v57, v110
    v_fmac_f32 v38, v58, v110
    v_fmac_f32 v39, v59, v110
    s_waitcnt lgkmcnt(2)
    v_fmac_f32 v32, v60, v112
    v_fmac_f32 v33, v61, v112
    v_fmac_f32 v34, v62, v112
    v_fmac_f32 v35, v63, v112
    v_fmac_f32 v36, v64, v112
    v_fmac_f32 v37, v65, v112
    v_fmac_f32 v38, v66, v112
    v_fmac_f32 v39, v67, v112
    s_waitcnt lgkmcnt(0)
    v_fmac_f32 v32, v68, v114
    v_fmac_f32 v33, v69, v114
    v_fmac_f32 v34, v70, v114
    v_fmac_f32 v35, v71, v114
    v_fmac_f32 v36, v72, v114
    v_fmac_f32 v37, v73, v114
    v_fmac_f32 v38, v74, v114
    v_fmac_f32 v39, v75, v114
    v_rcp_f32 v7, v7
    s_nop 0
    v_mul_f32 v32, v32, v7
    v_mul_f32 v33, v33, v7
    v_mul_f32 v34, v34, v7
    v_mul_f32 v35, v35, v7
    v_mul_f32 v36, v36, v7
    v_mul_f32 v37, v37, v7
    v_mul_f32 v38, v38, v7
    v_mul_f32 v39, v39, v7
    v_bfi_b32 v32, v10, s68, v32
    v_bfi_b32 v33, v10, s68, v33
    v_bfi_b32 v34, v10, s68, v34
    v_bfi_b32 v35, v10, s68, v35
    v_bfi_b32 v36, v10, s68, v36
    v_bfi_b32 v37, v10, s68, v37
    v_bfi_b32 v38, v10, s68, v38
    v_bfi_b32 v39, v10, s68, v39
    s_mov_b32 s6, 0x80000
    buffer_store_dwordx4 v[32:35], v17, s[52:55], s6 offen sc1
    buffer_store_dwordx4 v[36:39], v17, s[52:55], s6 offen offset:256 sc1
L_no_oa:
    s_barrier
    s_mov_b32 s6, 0x80000
    s_mov_b32 s7, 131072
L_spin_55:
    buffer_load_dwordx4 v[52:55], v20, s[52:55], s6 offen offset:0 sc1
    buffer_load_dwordx4 v[56:59], v20, s[52:55], s6 offen offset:256 sc1
    s_waitcnt vmcnt(0)
    v_xor_b32 v23, s68, v52
    v_bitop3_b32 v23, v23, v53, s68 bitop3:0xf6
    v_bitop3_b32 v23, v23, v54, s68 bitop3:0xf6
    v_bitop3_b32 v23, v23, v55, s68 bitop3:0xf6
    v_bitop3_b32 v23, v23, v56, s68 bitop3:0xf6
    v_bitop3_b32 v23, v23, v57, s68 bitop3:0xf6
    v_bitop3_b32 v23, v23, v58, s68 bitop3:0xf6
    v_bitop3_b32 v23, v23, v59, s68 bitop3:0xf6
    v_and_b32 v23, v23, v10
    v_cmp_ne_u32 vcc, 0, v23
    s_cbranch_vccz L_ok_56
    s_sub_u32 s7, s7, 1
    s_cmp_lg_u32 s7, 0
    s_cbranch_scc1 L_spin_55
L_ok_56:
    v_cvt_pk_bf16_f32 v40, v52, v53
    v_cvt_pk_bf16_f32 v41, v54, v55
    v_cvt_pk_bf16_f32 v42, v56, v57
    v_cvt_pk_bf16_f32 v43, v58, v59
    ds_write_b128 v1, v[40:43] offset:54272
    s_waitcnt lgkmcnt(0)
    ds_read_b128 v[44:47], v13 offset:54272
    ds_read_b128 v[48:51], v13 offset:54336
    ds_read_b128 v[52:55], v13 offset:54400
    ds_read_b128 v[56:59], v13 offset:54464
    s_waitcnt lgkmcnt(3)
    v_mfma_f32_16x16x32_bf16 v[60:63], v[160:163], v[44:47], 0
    v_mfma_f32_16x16x32_bf16 v[64:67], v[176:179], v[44:47], 0
    v_mfma_f32_16x16x32_bf16 v[68:71], v[192:195], v[44:47], 0
    v_mfma_f32_16x16x32_bf16 v[72:75], v[208:211], v[44:47], 0
    s_waitcnt lgkmcnt(2)
    v_mfma_f32_16x16x32_bf16 v[60:63], v[164:167], v[48:51], v[60:63]
    v_mfma_f32_16x16x32_bf16 v[64:67], v[180:183], v[48:51], v[64:67]
    v_mfma_f32_16x16x32_bf16 v[68:71], v[196:199], v[48:51], v[68:71]
    v_mfma_f32_16x16x32_bf16 v[72:75], v[212:215], v[48:51], v[72:75]
    s_waitcnt lgkmcnt(1)
    v_mfma_f32_16x16x32_bf16 v[60:63], v[168:171], v[52:55], v[60:63]
    v_mfma_f32_16x16x32_bf16 v[64:67], v[184:187], v[52:55], v[64:67]
    v_mfma_f32_16x16x32_bf16 v[68:71], v[200:203], v[52:55], v[68:71]
    v_mfma_f32_16x16x32_bf16 v[72:75], v[216:219], v[52:55], v[72:75]
    s_waitcnt lgkmcnt(0)
    v_mfma_f32_16x16x32_bf16 v[60:63], v[172:175], v[56:59], v[60:63]
    v_mfma_f32_16x16x32_bf16 v[64:67], v[188:191], v[56:59], v[64:67]
    v_mfma_f32_16x16x32_bf16 v[68:71], v[204:207], v[56:59], v[68:71]
    v_mfma_f32_16x16x32_bf16 v[72:75], v[220:223], v[56:59], v[72:75]
    s_lshl_b32 s6, s5, 11
    s_lshl_b32 s9, s4, 6
    s_add_u32 s6, s6, s9
    s_add_u32 s6, s6, 0x100000
    s_mov_b32 exec_lo, 0x000f000f
    s_mov_b32 exec_hi, 0x000f000f
    v_bfi_b32 v60, v10, s68, v60
    v_bfi_b32 v61, v10, s68, v61
    v_bfi_b32 v62, v10, s68, v62
    v_bfi_b32 v63, v10, s68, v63
    buffer_store_dwordx4 v[60:63], v14, s[52:55], s6 offen sc1
    s_add_u32 s6, s6, 131072
    v_bfi_b32 v64, v10, s68, v64
    v_bfi_b32 v65, v10, s68, v65
    v_bfi_b32 v66, v10, s68, v66
    v_bfi_b32 v67, v10, s68, v67
    buffer_store_dwordx4 v[64:67], v14, s[52:55], s6 offen sc1
    s_add_u32 s6, s6, 131072
    v_bfi_b32 v68, v10, s68, v68
    v_bfi_b32 v69, v10, s68, v69
    v_bfi_b32 v70, v10, s68, v70
    v_bfi_b32 v71, v10, s68, v71
    buffer_store_dwordx4 v[68:71], v14, s[52:55], s6 offen sc1
    s_add_u32 s6, s6, 131072
    v_bfi_b32 v72, v10, s68, v72
    v_bfi_b32 v73, v10, s68, v73
    v_bfi_b32 v74, v10, s68, v74
    v_bfi_b32 v75, v10, s68, v75
    buffer_store_dwordx4 v[72:75], v14, s[52:55], s6 offen sc1
    s_mov_b64 exec, -1
    s_endpgm
L_exit:
    s_endpgm
.section .rodata,"a"
.p2align 6
.amdhsa_kernel concat_heads__sliding_block_cached__mha_block_cached__decode_kernel
  .amdhsa_next_free_vgpr 256
  .amdhsa_next_free_sgpr 102
  .amdhsa_accum_offset 256
  .amdhsa_group_segment_fixed_size 0
  .amdhsa_kernarg_size 104
  .amdhsa_user_sgpr_count 2
  .amdhsa_user_sgpr_kernarg_segment_ptr 1
  .amdhsa_system_sgpr_workgroup_id_x 1
.end_amdhsa_kernel
```
